```python
import torch

def _softmax(x, axis=-1):
    return torch.softmax(x, dim=axis)
def _gelu(x):
    return torch.nn.functional.gelu(x, approximate="tanh")
def _silu(x):
    return torch.nn.functional.silu(x)
def _sigmoid(x):
    return torch.sigmoid(x)
def _layernorm(x, axis=-1, eps=1e-5):
    m = x.mean(dim=axis, keepdim=True)
    v = x.var(dim=axis, keepdim=True, unbiased=False)
    return (x - m) / torch.sqrt(v + eps)
def _scatter_add(tgt, idx, src, axis=0):
    return tgt.clone().index_add_(axis, idx, src)
def _segment_sum(src, seg, n):
    out = torch.zeros((n,) + src.shape[1:], dtype=src.dtype)
    return out.index_add_(0, seg, src)
def _pad(x, pw):
    flat = tuple(v for pair in reversed(pw) for v in pair)
    return torch.nn.functional.pad(x, flat)

kernel_name = 'concat_heads__sliding_block__ssm_conv_h3__prompt'

def setup_inputs():

    _w = (lambda a: (lambda t: t.to(torch.bfloat16) if t.is_floating_point() else t)(torch.as_tensor(a)))
    def _A_setup():
        B, S, D = 1, 2048, 640
        return {
            "x": _w((lambda *s: torch.randn(*s, dtype=torch.bfloat16) * 0.2)(B, S, D)),
            "wqkv": _w((lambda *s: torch.randn(*s, dtype=torch.bfloat16) * 0.2)(D, 3 * D)),
            "wo": _w((lambda *s: torch.randn(*s, dtype=torch.bfloat16) * 0.05)(D, D)),
        }
    _A_in = _A_setup()

    def _B_setup():
        B, S, D = 1, 2048, 640
        ks = 4
        return {
            "q": _w((lambda *s: torch.randn(*s, dtype=torch.bfloat16) * 0.05)(B, S, D)),
            "k": _w((lambda *s: torch.randn(*s, dtype=torch.bfloat16) * 0.8)(B, S, D)),
            "v": _w((lambda *s: torch.randn(*s, dtype=torch.bfloat16) * 0.8)(B, S, D)),
            "shift_k": _w((lambda *s: torch.randn(*s, dtype=torch.bfloat16) * 0.8)(D, ks) * 0.5),
            "ssm_k": _w((lambda *s: torch.randn(*s, dtype=torch.bfloat16) * 3.2)(D, S) * (1.0 / S ** 0.5)),
            "ssm_D": _w((lambda *s: torch.randn(*s, dtype=torch.bfloat16) * 0.8)(D)),
        }
    _B_in = _B_setup()

    return {
        "A_x": _A_in["x"],
        "A_wqkv": _A_in["wqkv"],
        "A_wo": _A_in["wo"],
        "B_q": _B_in["q"],
        "B_k": _B_in["k"],
        "B_v": _B_in["v"],
        "B_shift_k": _B_in["shift_k"],
        "B_ssm_k": _B_in["ssm_k"],
        "B_ssm_D": _B_in["ssm_D"],
    }

def reference(A_x, A_wqkv, A_wo, B_q, B_k, B_v, B_shift_k, B_ssm_k, B_ssm_D):
    def _A_ref(x, wqkv, wo):
        B, S, D = x.shape
        H = 32; Dh = D // H; W = 256
        qkv = (lambda x, *d: x.permute(*d))((x @ wqkv).reshape(B, S, 3, H, Dh), 2, 0, 3, 1, 4)
        q, k, v = qkv[0], qkv[1], qkv[2]
        scores = torch.einsum("bhqd,bhkd->bhqk", q, k) * (Dh ** -0.5)
        idx = torch.arange(S)
        mask = (idx[:, None] - idx[None, :] >= 0) & (idx[:, None] - idx[None, :] < W)
        scores = torch.where(mask[None, None], scores, -1e9)
        p = _softmax(scores, axis=-1)
        o = torch.einsum("bhqk,bhkd->bhqd", p, v)
        return (lambda x, *d: x.permute(*d))(o, 0, 2, 1, 3).reshape(B, S, D) @ wo

    def _B_ref(q, k, v, shift_k, ssm_k, ssm_D):
        B, S, D = q.shape
        ks = shift_k.shape[-1]
        k_pad = _pad(k, ((0, 0), (ks - 1, 0), (0, 0)))
        k_shift = torch.zeros_like(k)
        for t in range(ks):
            k_shift = k_shift + k_pad[:, t:t + S, :] * shift_k[:, ks - 1 - t][None, None, :]
        kv = k_shift * v
        L = 2 * S
        kv_pad = _pad(kv, ((0, 0), (0, S), (0, 0)))
        kf_pad = _pad(ssm_k, ((0, 0), (0, S)))
        kv_f = (lambda x, axes=(-2,-1): torch.fft.rfft2(x.float(), dim=axes))(kv_pad[:, None, :, :], axes=(1, 2))
        kf_f = (lambda x, axes=(-2,-1): torch.fft.rfft2(x.float(), dim=axes))(kf_pad[:, None, :], axes=(1, 2))
        kf_f = (lambda x, *d: x.permute(*d))(kf_f, 1, 2, 0)
        y_f = kv_f * kf_f[None, :, :, :]
        y = (lambda x, s, axes=(-2,-1): torch.fft.irfft2(x, s=s, dim=axes).to(torch.bfloat16))(y_f, (1, L), axes=(1, 2))[:, 0, :S, :]
        y = y + kv * ssm_D[None, None, :]
        return q * y

    a = _A_ref(A_x, A_wqkv, A_wo)
    b = _B_ref(B_q, B_k, B_v, B_shift_k, B_ssm_k, B_ssm_D)
    return torch.concatenate([a, b], axis=-1)
```

```asm
; @launch grid=(256,1,1) block=(512,1,1) lds=163840
.amdgcn_target "amdgcn-amd-amdhsa--gfx950"
.text
.globl concat_heads__sliding_block__ssm_conv_h3__prompt_kernel
.p2align 8
.type concat_heads__sliding_block__ssm_conv_h3__prompt_kernel,@function
concat_heads__sliding_block__ssm_conv_h3__prompt_kernel:
    s_load_dwordx2 s[24:25], s[0:1], 32
    s_load_dwordx2 s[28:29], s[0:1], 40
    s_load_dwordx2 s[32:33], s[0:1], 48
    s_load_dwordx2 s[8:9], s[0:1], 0
    s_load_dwordx2 s[12:13], s[0:1], 8
    s_cmp_ge_u32 s2, 256
    s_cbranch_scc1 L_exit
    v_lshrrev_b32 v2, 6, v0
    v_and_b32 v1, 63, v0
    s_and_b32 s57, s2, 7
    v_readfirstlane_b32 s56, v2
    s_lshr_b32 s58, s2, 3
    v_mul_u32_u24 v2, 26, v1
    s_and_b32 s70, s58, 3
    v_lshrrev_b32 v2, 8, v2
    s_lshl2_add_u32 s62, s57, s70
    v_mul_u32_u24 v2, 1120, v2
    s_lshr_b32 s63, s58, 2
    v_lshl_add_u32 v12, v1, 4, v2
    s_mul_i32 s7, s63, 160
    s_lshl3_add_u32 s71, s62, s56
    s_mul_i32 s71, s71, 10240
    s_add_u32 s71, s71, s7
    s_mul_i32 s83, s56, 1296
    s_mov_b32 s26, 2621440
    s_mov_b32 s27, 0x20000
    s_mov_b32 s30, 2621440
    s_mov_b32 s31, 0x20000
    s_add_u32 s72, s71, 5120
    s_cmp_lg_u32 s56, 7
    s_cbranch_scc1 L_nocp
    s_getpc_b64 s[4:5]
L_pc:
    s_mul_i32 s3, s58, 1408
    v_lshl_add_u32 v2, v1, 7, s3
    v_min_u32 v2, L_end-L_pc, v2
    v_mov_b32 v3, 119728
    v_mov_b32 v4, 0
    s_mov_b64 exec, 0x7ff
    global_load_dword v62, v2, s[4:5]
    ds_write_b32 v3, v4
    s_mov_b32 exec_lo, -1
L_nocp:
    s_mov_b32 exec_hi, 0xff
    s_add_u32 m0, s83, 98960
    s_waitcnt lgkmcnt(0)
    buffer_load_dwordx4 v12, s[24:27], s71 offen  lds
    s_add_u32 m0, s83, 109328
    s_nop 0
    buffer_load_dwordx4 v12, s[28:31], s71 offen  lds
    s_add_u32 m0, s83, 99600
    s_nop 0
    buffer_load_dwordx4 v12, s[24:27], s72 offen  lds
    s_add_u32 m0, s83, 109968
    s_nop 0
    buffer_load_dwordx4 v12, s[28:31], s72 offen  lds
    s_cmp_lg_u32 s56, 0
    s_cbranch_scc1 L_nohalo
    s_sub_u32 s71, s71, 5120
    v_add_u32 v13, s71, v12
    s_mov_b32 m0, 98304
    s_nop 0
    buffer_load_dwordx4 v13, s[24:27], 0 offen  lds
L_nohalo:
    s_mov_b32 exec_hi, -1
    s_mov_b32 s34, 5120
    s_mov_b32 s35, 0x20000
    s_cmp_ge_u32 s56, 4
    s_cbranch_scc1 L_nosh
    v_lshrrev_b32 v4, 3, v0
    v_lshlrev_b32 v4, 4, v4
    s_mul_i32 s74, s63, 640
    buffer_load_dwordx4 v[8:11], v4, s[32:35], s74 offen
    v_lshrrev_b32 v4, 5, v0
    v_lshlrev_b32 v4, 4, v4
    buffer_load_dwordx4 v[184:187], v4, s[32:35], s74 offen offset:512
L_nosh:
    s_load_dwordx2 s[48:49], s[0:1], 80
    s_load_dwordx2 s[52:53], s[0:1], 88
    s_load_dwordx2 s[36:37], s[0:1], 56
    s_load_dwordx2 s[40:41], s[0:1], 64
    s_load_dwordx2 s[16:17], s[0:1], 16
    s_load_dwordx2 s[20:21], s[0:1], 24
    s_load_dwordx2 s[44:45], s[0:1], 72
    s_and_b32 s59, s56, 3
    s_and_b32 s70, s57, 1
    s_mul_i32 s70, s70, 30
    s_add_u32 s70, s70, s58
    s_lshr_b32 s65, s70, 2
    s_cmp_ge_u32 s58, 30
    s_cselect_b32 s65, 7, s65
    s_and_b32 s70, s70, 3
    s_lshr_b32 s64, s57, 1
    s_lshl2_add_u32 s64, s64, s70
    s_barrier
    s_mov_b32 s68, s62
    s_mov_b32 s69, s63
    s_cmp_lt_u32 s56, 4
    s_cbranch_scc1 L_C
    s_mov_b32 s10, 2621440
    s_mov_b32 s11, 0x20000
    s_mov_b32 s14, 2457600
    s_mov_b32 s15, 0x20000
    v_lshrrev_b32 v2, 3, v1
    v_lshrrev_b32 v3, 4, v1
    v_xor_b32 v4, v3, v1
    v_and_b32 v4, 7, v4
    v_mul_u32_u24 v2, 1280, v2
    v_lshl_add_u32 v16, v4, 4, v2
    v_xor_b32 v4, 4, v4
    v_lshl_add_u32 v17, v4, 4, v2
    v_add_u32 v17, 10240, v17
    v_add_u32 v18, 20480, v16
    v_add_u32 v19, 20480, v17
    v_lshlrev_b32 v4, 2, v3
    v_xor_b32 v4, v4, v1
    v_and_b32 v4, 15, v4
    v_mul_u32_u24 v3, 3840, v3
    v_lshl_add_u32 v20, v4, 4, v3
    v_xor_b32 v63, 32, v20
    s_mul_i32 s82, s64, 163840
    s_mul_i32 s70, s59, 40960
    s_add_u32 s82, s82, s70
    s_lshl_b32 s83, s65, 8
    s_mul_i32 s70, s59, 61440
    s_add_u32 s83, s83, s70
    s_lshl_b32 s75, s59, 12
    s_add_u32 s70, s64, s65
    s_mul_i32 s71, s70, 86
    s_lshr_b32 s71, s71, 8
    s_mul_i32 s71, s71, 3
    s_sub_u32 s70, s70, s71
    s_mul_i32 s70, s70, 7
    s_lshr_b32 s70, s70, 1
    s_mul_i32 s71, s57, 1
    s_add_u32 s79, s70, s71
    s_mul_i32 s70, s79, 205
    s_lshr_b32 s70, s70, 11
    s_mul_i32 s70, s70, 10
    s_sub_u32 s79, s79, s70
    s_cmp_ge_u32 s58, 30
    s_cbranch_scc1 L_h_idle
    s_lshl_b32 s70, s79, 7
    s_add_u32 s70, s70, s82
    s_mul_i32 s71, s79, 245760
    s_add_u32 s71, s71, s83
    s_add_u32 m0, s75, 32768
    s_nop 0
    buffer_load_dwordx4 v16, s[8:11], s70 offen  lds
    s_add_u32 m0, s75, 49152
    s_nop 0
    buffer_load_dwordx4 v20, s[12:15], s71 offen  lds
    s_add_u32 s71, s71, 15360
    s_add_u32 m0, s75, 33792
    s_nop 0
    buffer_load_dwordx4 v17, s[8:11], s70 offen  lds
    s_add_u32 m0, s75, 50176
    s_nop 0
    buffer_load_dwordx4 v20, s[12:15], s71 offen  lds
    s_add_u32 s71, s71, 15360
    s_add_u32 m0, s75, 34816
    s_nop 0
    buffer_load_dwordx4 v18, s[8:11], s70 offen  lds
    s_add_u32 m0, s75, 51200
    s_nop 0
    buffer_load_dwordx4 v63, s[12:15], s71 offen  lds
    s_add_u32 s71, s71, 15360
    s_add_u32 m0, s75, 35840
    s_nop 0
    buffer_load_dwordx4 v19, s[8:11], s70 offen  lds
    s_add_u32 m0, s75, 52224
    s_nop 0
    buffer_load_dwordx4 v63, s[12:15], s71 offen  lds
    s_add_u32 s79, s79, 1
    s_cmp_eq_u32 s79, 10
    s_cselect_b32 s79, 0, s79
    v_mov_b32 v2, 119728
    v_mov_b32 v3, 1
    s_waitcnt vmcnt(8)
    s_mov_b64 exec, 1
    ds_add_u32 v2, v3
    s_mov_b64 exec, -1
    s_lshl_b32 s70, s79, 7
    s_add_u32 s70, s70, s82
    s_mul_i32 s71, s79, 245760
    s_add_u32 s71, s71, s83
    s_add_u32 m0, s75, 65536
    s_nop 0
    buffer_load_dwordx4 v16, s[8:11], s70 offen  lds
    s_add_u32 m0, s75, 81920
    s_nop 0
    buffer_load_dwordx4 v20, s[12:15], s71 offen  lds
    s_add_u32 s71, s71, 15360
    s_add_u32 m0, s75, 66560
    s_nop 0
    buffer_load_dwordx4 v17, s[8:11], s70 offen  lds
    s_add_u32 m0, s75, 82944
    s_nop 0
    buffer_load_dwordx4 v20, s[12:15], s71 offen  lds
    s_add_u32 s71, s71, 15360
    s_add_u32 m0, s75, 67584
    s_nop 0
    buffer_load_dwordx4 v18, s[8:11], s70 offen  lds
    s_add_u32 m0, s75, 83968
    s_nop 0
    buffer_load_dwordx4 v63, s[12:15], s71 offen  lds
    s_add_u32 s71, s71, 15360
    s_add_u32 m0, s75, 68608
    s_nop 0
    buffer_load_dwordx4 v19, s[8:11], s70 offen  lds
    s_add_u32 m0, s75, 84992
    s_nop 0
    buffer_load_dwordx4 v63, s[12:15], s71 offen  lds
    s_add_u32 s79, s79, 1
    s_cmp_eq_u32 s79, 10
    s_cselect_b32 s79, 0, s79
    s_mov_b32 s18, 819200
    s_mov_b32 s19, 0x20000
    s_mov_b32 s22, 2621440
    s_mov_b32 s23, 0x20000
    s_mov_b32 s38, 2621440
    s_mov_b32 s39, 0x20000
    s_mov_b32 s42, 1280
    s_mov_b32 s43, 0x20000
    s_mov_b32 s46, 5242880
    s_mov_b32 s47, 0x20000
    s_mov_b32 s50, 256
    s_mov_b32 s51, 0x20000
    s_mov_b32 s54, 25165824
    s_mov_b32 s55, 0x20000
    s_mul_i32 s70, s58, 3
    s_lshl_b32 s71, s58, 1
    s_add_u32 s71, s71, 16
    s_cmp_lt_u32 s58, 16
    s_cselect_b32 s70, s70, s71
    s_cselect_b32 s71, 3, 2
    s_cmp_lt_u32 s70, 80
    s_cselect_b32 s71, s71, 0
    s_cselect_b32 s70, s70, 0
    s_cmp_lt_u32 s59, s71
    s_cselect_b32 s67, 1, 0
    s_cselect_b32 s71, s59, 0
    s_add_u32 s70, s70, s71
    s_mul_i32 s66, s57, 80
    s_add_u32 s66, s66, s70
    s_bfe_u32 s71, s70, 0x20002
    s_cmp_lt_u32 s70, 64
    s_cselect_b32 s72, 4, 31
    s_cselect_b32 s71, 0, s71
    s_lshr_b32 s70, s70, s72
    s_add_u32 s70, s70, s71
    s_lshl_b32 s71, s57, 2
    s_add_u32 s70, s70, s71
    s_lshl_b32 s70, s70, 5
    v_and_b32 v12, 31, v1
    v_add_u32 v12, s70, v12
    v_mul_u32_u24 v12, 8, v12
    v_add_u32 v12, 18087936, v12
    v_and_b32 v2, 15, v1
    v_lshrrev_b32 v3, 4, v1
    v_add_u32 v4, 1, v2
    v_lshrrev_b32 v4, 1, v4
    v_lshl_add_u32 v4, v3, 2, v4
    v_lshlrev_b32 v4, 2, v4
    v_and_b32 v5, 1, v2
    v_cmp_eq_u32 vcc, 0, v5
    v_mov_b32 v5, 4160
    s_nop 0
    v_cndmask_b32 v5, 0, v5, vcc
    s_mul_i32 s71, s59, s67
    s_mul_i32 s70, s71, 8320
    s_add_u32 s70, s70, 119808
    v_add3_u32 v26, v4, v5, s70
    v_add_u32 v27, 1024, v26
    v_add_u32 v28, 2048, v26
    v_add_u32 v29, 3072, v26
    v_lshlrev_b32 v13, 4, v1
    v_add_u32 v25, s70, v13
    v_lshlrev_b32 v4, 5, v2
    v_lshl_add_u32 v4, v3, 3, v4
    s_lshl_b32 s70, s59, 12
    s_add_u32 s70, s70, 98304
    v_add_u32 v31, s70, v4
    v_add_u32 v180, s70, v13
    v_sub_u32 v4, 15, v2
    v_lshlrev_b32 v4, 5, v4
    v_lshl_add_u32 v4, v3, 4, v4
    s_mul_i32 s71, s71, 4608
    s_add_u32 s71, s71, 144768
    v_add_u32 v30, s71, v4
    v_lshl_add_u32 v2, v1, 3, s71
    v_mov_b32 v4, 0
    v_mov_b32 v5, 0
    v_mov_b32 v6, 0
    v_mov_b32 v7, 0
    ds_write_b64 v2, v[4:5] offset:4096
    s_mov_b64 exec, 3
    ds_write_b128 v25, v[4:7]
    ds_write_b128 v25, v[4:7] offset:4160
    s_mov_b64 exec, -1
    v_mov_b32 v199, 0
    v_mov_b32 v189, 0
    s_waitcnt lgkmcnt(0)
    s_waitcnt vmcnt(8)
    s_barrier
    v_mov_b32 v24, 0
    buffer_load_dwordx2 v[22:23], v24, s[48:51], 0 offen sc1
    s_lshl_b32 s70, s79, 7
    s_add_u32 s70, s70, s82
    s_mul_i32 s71, s79, 245760
    s_add_u32 s71, s71, s83
    s_add_u32 m0, s75, 0
    s_nop 0
    buffer_load_dwordx4 v16, s[8:11], s70 offen  lds
    s_add_u32 m0, s75, 16384
    s_nop 0
    buffer_load_dwordx4 v20, s[12:15], s71 offen  lds
    s_add_u32 s71, s71, 15360
    s_add_u32 m0, s75, 1024
    s_nop 0
    buffer_load_dwordx4 v17, s[8:11], s70 offen  lds
    s_add_u32 m0, s75, 17408
    s_nop 0
    buffer_load_dwordx4 v20, s[12:15], s71 offen  lds
    s_add_u32 s71, s71, 15360
    s_add_u32 m0, s75, 2048
    s_nop 0
    buffer_load_dwordx4 v18, s[8:11], s70 offen  lds
    s_add_u32 m0, s75, 18432
    s_nop 0
    buffer_load_dwordx4 v63, s[12:15], s71 offen  lds
    s_add_u32 s71, s71, 15360
    s_add_u32 m0, s75, 3072
    s_nop 0
    buffer_load_dwordx4 v19, s[8:11], s70 offen  lds
    s_add_u32 m0, s75, 19456
    s_nop 0
    buffer_load_dwordx4 v63, s[12:15], s71 offen  lds
    s_add_u32 s79, s79, 1
    s_cmp_eq_u32 s79, 10
    s_cselect_b32 s79, 0, s79
    s_mul_i32 s71, s59, s67
    s_sub_u32 s70, s66, s71
    s_lshl_b32 s70, s70, 12
    s_lshl_b32 s71, s59, 6
    s_add_u32 s70, s70, s71
    s_add_u32 s24, s36, s70
    s_addc_u32 s25, s37, 0
    s_sub_u32 s26, s38, s70
    s_mov_b32 s27, 0x20000
    s_buffer_load_dword s28, s[24:27], 0
    s_buffer_load_dword s28, s[24:27], 256
    s_buffer_load_dword s28, s[24:27], 512
    s_buffer_load_dword s28, s[24:27], 768
    s_buffer_load_dword s28, s[24:27], 1024
    s_buffer_load_dword s28, s[24:27], 1280
    s_buffer_load_dword s28, s[24:27], 1536
    s_waitcnt vmcnt(9)
    s_barrier
    s_lshl_b32 s70, s79, 7
    s_add_u32 s70, s70, s82
    s_mul_i32 s71, s79, 245760
    s_add_u32 s71, s71, s83
    s_add_u32 m0, s75, 32768
    s_nop 0
    buffer_load_dwordx4 v16, s[8:11], s70 offen  lds
    s_add_u32 m0, s75, 49152
    s_nop 0
    buffer_load_dwordx4 v20, s[12:15], s71 offen  lds
    s_add_u32 s71, s71, 15360
    s_add_u32 m0, s75, 33792
    s_nop 0
    buffer_load_dwordx4 v17, s[8:11], s70 offen  lds
    s_add_u32 m0, s75, 50176
    s_nop 0
    buffer_load_dwordx4 v20, s[12:15], s71 offen  lds
    s_add_u32 s71, s71, 15360
    s_add_u32 m0, s75, 34816
    s_nop 0
    buffer_load_dwordx4 v18, s[8:11], s70 offen  lds
    s_add_u32 m0, s75, 51200
    s_nop 0
    buffer_load_dwordx4 v63, s[12:15], s71 offen  lds
    s_add_u32 s71, s71, 15360
    s_add_u32 m0, s75, 35840
    s_nop 0
    buffer_load_dwordx4 v19, s[8:11], s70 offen  lds
    s_add_u32 m0, s75, 52224
    s_nop 0
    buffer_load_dwordx4 v63, s[12:15], s71 offen  lds
    s_add_u32 s79, s79, 1
    s_cmp_eq_u32 s79, 10
    s_cselect_b32 s79, 0, s79
    s_buffer_load_dword s28, s[24:27], 1792
    s_buffer_load_dword s28, s[24:27], 2048
    s_buffer_load_dword s28, s[24:27], 2304
    s_buffer_load_dword s28, s[24:27], 2560
    s_buffer_load_dword s28, s[24:27], 2816
    s_buffer_load_dword s28, s[24:27], 3072
    s_buffer_load_dword s28, s[24:27], 3328
    s_waitcnt vmcnt(8)
    s_barrier
    s_lshl_b32 s70, s79, 7
    s_add_u32 s70, s70, s82
    s_mul_i32 s71, s79, 245760
    s_add_u32 s71, s71, s83
    s_add_u32 m0, s75, 65536
    s_nop 0
    buffer_load_dwordx4 v16, s[8:11], s70 offen  lds
    s_add_u32 m0, s75, 81920
    s_nop 0
    buffer_load_dwordx4 v20, s[12:15], s71 offen  lds
    s_add_u32 s71, s71, 15360
    s_add_u32 m0, s75, 66560
    s_nop 0
    buffer_load_dwordx4 v17, s[8:11], s70 offen  lds
    s_add_u32 m0, s75, 82944
    s_nop 0
    buffer_load_dwordx4 v20, s[12:15], s71 offen  lds
    s_add_u32 s71, s71, 15360
    s_add_u32 m0, s75, 67584
    s_nop 0
    buffer_load_dwordx4 v18, s[8:11], s70 offen  lds
    s_add_u32 m0, s75, 83968
    s_nop 0
    buffer_load_dwordx4 v63, s[12:15], s71 offen  lds
    s_add_u32 s71, s71, 15360
    s_add_u32 m0, s75, 68608
    s_nop 0
    buffer_load_dwordx4 v19, s[8:11], s70 offen  lds
    s_add_u32 m0, s75, 84992
    s_nop 0
    buffer_load_dwordx4 v63, s[12:15], s71 offen  lds
    s_add_u32 s79, s79, 1
    s_cmp_eq_u32 s79, 10
    s_cselect_b32 s79, 0, s79
    s_buffer_load_dword s28, s[24:27], 3584
    s_buffer_load_dword s28, s[24:27], 3840
    s_buffer_load_dword s28, s[24:27], 4096
    s_buffer_load_dword s28, s[24:27], 4352
    s_buffer_load_dword s28, s[24:27], 4608
    s_buffer_load_dword s28, s[24:27], 4864
    s_buffer_load_dword s28, s[24:27], 5120
    s_mov_b32 s76, 0
L_nonr_2:
    v_readfirstlane_b32 s60, v22
    v_readfirstlane_b32 s61, v23
    s_cmp_eq_u32 s60, 0
    s_cbranch_scc1 L_non_1
L_nond_3:
    s_waitcnt vmcnt(8)
    s_barrier
    s_lshl_b32 s70, s79, 7
    s_add_u32 s70, s70, s82
    s_mul_i32 s71, s79, 245760
    s_add_u32 s71, s71, s83
    s_add_u32 m0, s75, 0
    s_nop 0
    buffer_load_dwordx4 v16, s[8:11], s70 offen  lds
    s_add_u32 m0, s75, 16384
    s_nop 0
    buffer_load_dwordx4 v20, s[12:15], s71 offen  lds
    s_add_u32 s71, s71, 15360
    s_add_u32 m0, s75, 1024
    s_nop 0
    buffer_load_dwordx4 v17, s[8:11], s70 offen  lds
    s_add_u32 m0, s75, 17408
    s_nop 0
    buffer_load_dwordx4 v20, s[12:15], s71 offen  lds
    s_add_u32 s71, s71, 15360
    s_add_u32 m0, s75, 2048
    s_nop 0
    buffer_load_dwordx4 v18, s[8:11], s70 offen  lds
    s_add_u32 m0, s75, 18432
    s_nop 0
    buffer_load_dwordx4 v63, s[12:15], s71 offen  lds
    s_add_u32 s71, s71, 15360
    s_add_u32 m0, s75, 3072
    s_nop 0
    buffer_load_dwordx4 v19, s[8:11], s70 offen  lds
    s_add_u32 m0, s75, 19456
    s_nop 0
    buffer_load_dwordx4 v63, s[12:15], s71 offen  lds
    s_add_u32 s79, s79, 1
    s_cmp_eq_u32 s79, 10
    s_cselect_b32 s79, 0, s79
    s_buffer_load_dword s28, s[24:27], 5376
    s_buffer_load_dword s28, s[24:27], 5632
    s_buffer_load_dword s28, s[24:27], 5888
    s_buffer_load_dword s28, s[24:27], 6144
    s_buffer_load_dword s28, s[24:27], 6400
    s_buffer_load_dword s28, s[24:27], 6656
    s_buffer_load_dword s28, s[24:27], 6912
    s_waitcnt vmcnt(8)
    s_barrier
    s_lshl_b32 s70, s79, 7
    s_add_u32 s70, s70, s82
    s_mul_i32 s71, s79, 245760
    s_add_u32 s71, s71, s83
    s_add_u32 m0, s75, 32768
    s_nop 0
    buffer_load_dwordx4 v16, s[8:11], s70 offen  lds
    s_add_u32 m0, s75, 49152
    s_nop 0
    buffer_load_dwordx4 v20, s[12:15], s71 offen  lds
    s_add_u32 s71, s71, 15360
    s_add_u32 m0, s75, 33792
    s_nop 0
    buffer_load_dwordx4 v17, s[8:11], s70 offen  lds
    s_add_u32 m0, s75, 50176
    s_nop 0
    buffer_load_dwordx4 v20, s[12:15], s71 offen  lds
    s_add_u32 s71, s71, 15360
    s_add_u32 m0, s75, 34816
    s_nop 0
    buffer_load_dwordx4 v18, s[8:11], s70 offen  lds
    s_add_u32 m0, s75, 51200
    s_nop 0
    buffer_load_dwordx4 v63, s[12:15], s71 offen  lds
    s_add_u32 s71, s71, 15360
    s_add_u32 m0, s75, 35840
    s_nop 0
    buffer_load_dwordx4 v19, s[8:11], s70 offen  lds
    s_add_u32 m0, s75, 52224
    s_nop 0
    buffer_load_dwordx4 v63, s[12:15], s71 offen  lds
    s_add_u32 s79, s79, 1
    s_cmp_eq_u32 s79, 10
    s_cselect_b32 s79, 0, s79
    s_buffer_load_dword s28, s[24:27], 7168
    s_buffer_load_dword s28, s[24:27], 7424
    s_buffer_load_dword s28, s[24:27], 7680
    s_buffer_load_dword s28, s[24:27], 7936
    s_buffer_load_dword s28, s[24:27], 8192
    s_buffer_load_dword s28, s[24:27], 8448
    s_buffer_load_dword s28, s[24:27], 8704
    s_waitcnt vmcnt(8)
    s_barrier
    s_lshl_b32 s70, s79, 7
    s_add_u32 s70, s70, s82
    s_mul_i32 s71, s79, 245760
    s_add_u32 s71, s71, s83
    s_add_u32 m0, s75, 65536
    s_nop 0
    buffer_load_dwordx4 v16, s[8:11], s70 offen  lds
    s_add_u32 m0, s75, 81920
    s_nop 0
    buffer_load_dwordx4 v20, s[12:15], s71 offen  lds
    s_add_u32 s71, s71, 15360
    s_add_u32 m0, s75, 66560
    s_nop 0
    buffer_load_dwordx4 v17, s[8:11], s70 offen  lds
    s_add_u32 m0, s75, 82944
    s_nop 0
    buffer_load_dwordx4 v20, s[12:15], s71 offen  lds
    s_add_u32 s71, s71, 15360
    s_add_u32 m0, s75, 67584
    s_nop 0
    buffer_load_dwordx4 v18, s[8:11], s70 offen  lds
    s_add_u32 m0, s75, 83968
    s_nop 0
    buffer_load_dwordx4 v63, s[12:15], s71 offen  lds
    s_add_u32 s71, s71, 15360
    s_add_u32 m0, s75, 68608
    s_nop 0
    buffer_load_dwordx4 v19, s[8:11], s70 offen  lds
    s_add_u32 m0, s75, 84992
    s_nop 0
    buffer_load_dwordx4 v63, s[12:15], s71 offen  lds
    s_add_u32 s79, s79, 1
    s_cmp_eq_u32 s79, 10
    s_cselect_b32 s79, 0, s79
    s_buffer_load_dword s28, s[24:27], 8960
    s_buffer_load_dword s28, s[24:27], 9216
    s_buffer_load_dword s28, s[24:27], 9472
    s_buffer_load_dword s28, s[24:27], 9728
    s_buffer_load_dword s28, s[24:27], 9984
    s_buffer_load_dword s28, s[24:27], 10240
    s_buffer_load_dword s28, s[24:27], 10496
    s_waitcnt vmcnt(8)
    s_barrier
    buffer_load_dwordx2 v[14:15], v12, s[52:55], 0 offen sc1
    s_lshl_b32 s70, s79, 7
    s_add_u32 s70, s70, s82
    s_mul_i32 s71, s79, 245760
    s_add_u32 s71, s71, s83
    s_add_u32 m0, s75, 0
    s_nop 0
    buffer_load_dwordx4 v16, s[8:11], s70 offen  lds
    s_add_u32 m0, s75, 16384
    s_nop 0
    buffer_load_dwordx4 v20, s[12:15], s71 offen  lds
    s_add_u32 s71, s71, 15360
    s_add_u32 m0, s75, 1024
    s_nop 0
    buffer_load_dwordx4 v17, s[8:11], s70 offen  lds
    s_add_u32 m0, s75, 17408
    s_nop 0
    buffer_load_dwordx4 v20, s[12:15], s71 offen  lds
    s_add_u32 s71, s71, 15360
    s_add_u32 m0, s75, 2048
    s_nop 0
    buffer_load_dwordx4 v18, s[8:11], s70 offen  lds
    s_add_u32 m0, s75, 18432
    s_nop 0
    buffer_load_dwordx4 v63, s[12:15], s71 offen  lds
    s_add_u32 s71, s71, 15360
    s_add_u32 m0, s75, 3072
    s_nop 0
    buffer_load_dwordx4 v19, s[8:11], s70 offen  lds
    s_add_u32 m0, s75, 19456
    s_nop 0
    buffer_load_dwordx4 v63, s[12:15], s71 offen  lds
    s_add_u32 s79, s79, 1
    s_cmp_eq_u32 s79, 10
    s_cselect_b32 s79, 0, s79
    s_buffer_load_dword s28, s[24:27], 10752
    s_buffer_load_dword s28, s[24:27], 11008
    s_buffer_load_dword s28, s[24:27], 11264
    s_buffer_load_dword s28, s[24:27], 11520
    s_buffer_load_dword s28, s[24:27], 11776
    s_buffer_load_dword s28, s[24:27], 12032
    s_waitcnt vmcnt(9)
    s_barrier
    s_lshl_b32 s70, s79, 7
    s_add_u32 s70, s70, s82
    s_mul_i32 s71, s79, 245760
    s_add_u32 s71, s71, s83
    s_add_u32 m0, s75, 32768
    s_nop 0
    buffer_load_dwordx4 v16, s[8:11], s70 offen  lds
    s_add_u32 m0, s75, 49152
    s_nop 0
    buffer_load_dwordx4 v20, s[12:15], s71 offen  lds
    s_add_u32 s71, s71, 15360
    s_add_u32 m0, s75, 33792
    s_nop 0
    buffer_load_dwordx4 v17, s[8:11], s70 offen  lds
    s_add_u32 m0, s75, 50176
    s_nop 0
    buffer_load_dwordx4 v20, s[12:15], s71 offen  lds
    s_add_u32 s71, s71, 15360
    s_add_u32 m0, s75, 34816
    s_nop 0
    buffer_load_dwordx4 v18, s[8:11], s70 offen  lds
    s_add_u32 m0, s75, 51200
    s_nop 0
    buffer_load_dwordx4 v63, s[12:15], s71 offen  lds
    s_add_u32 s71, s71, 15360
    s_add_u32 m0, s75, 35840
    s_nop 0
    buffer_load_dwordx4 v19, s[8:11], s70 offen  lds
    s_add_u32 m0, s75, 52224
    s_nop 0
    buffer_load_dwordx4 v63, s[12:15], s71 offen  lds
    s_add_u32 s79, s79, 1
    s_cmp_eq_u32 s79, 10
    s_cselect_b32 s79, 0, s79
    s_cmp_eq_u32 s67, 0
    s_cbranch_scc1 L_h_nob2a
    s_waitcnt vmcnt(8)
    s_barrier
    s_mul_i32 s73, s59, 8320
    s_mul_i32 s73, s73, s67
    s_lshl_b32 s70, s66, 12
    s_add_u32 m0, s73, 119840
    s_lshl_b32 s74, s66, 1
    v_mov_b32 v4, s74
    buffer_load_dwordx4 v13, s[36:39], s70 offen offset:0  lds
    buffer_load_dwordx4 v13, s[36:39], s70 offen offset:1024  lds
    buffer_load_dwordx4 v13, s[36:39], s70 offen offset:2048  lds
    buffer_load_dwordx4 v13, s[36:39], s70 offen offset:3072  lds
    buffer_load_ushort v21, v4, s[40:43], 0 offen
    v_cmp_ne_u32 vcc, s60, v14
    v_cmp_ne_u32 s[80:81], s61, v15
    s_nop 0
    s_or_b64 vcc, vcc, s[80:81]
    s_cbranch_vccnz L_cp_4
L_cpr_5:
    s_mul_i32 s72, s59, 4608
    s_lshl_b32 s70, s66, 12
    s_add_u32 s71, s70, 8388608
    s_add_u32 m0, s72, 144768
    s_nop 0
    buffer_load_dwordx4 v13, s[52:55], s71 offen offset:0 sc1 lds
    buffer_load_dwordx4 v13, s[52:55], s71 offen offset:1024 sc1 lds
    buffer_load_dwordx4 v13, s[52:55], s71 offen offset:2048 sc1 lds
    buffer_load_dwordx4 v13, s[52:55], s71 offen offset:3072 sc1 lds
    s_waitcnt vmcnt(9)
    s_barrier
L_h_post:
    s_waitcnt vmcnt(4) lgkmcnt(0)
    ds_read_b128 v[64:67], v25 offset:32
    ds_read_b32 v68, v25 offset:48
    ds_read_b128 v[70:73], v25 offset:1056
    ds_read_b32 v74, v25 offset:1072
    ds_read_b128 v[76:79], v25 offset:2080
    ds_read_b32 v80, v25 offset:2096
    ds_read_b128 v[82:85], v25 offset:3104
    ds_read_b32 v86, v25 offset:3120
    v_and_b32 v2, 15, v1
    v_sub_u32 v2, 15, v2
    v_lshrrev_b32 v3, 4, v1
    v_lshlrev_b32 v3, 2, v3
    v_lshrrev_b32 v4, 1, v2
    v_sub_u32 v4, v4, v3
    v_and_b32 v2, 1, v2
    v_lshlrev_b32 v2, 4, v2
    v_lshlrev_b32 v2, v2, v21
    v_cmp_eq_u32 vcc, 0, v4
    s_nop 1
    v_cndmask_b32 v148, 0, v2, vcc
    v_cmp_eq_u32 vcc, 1, v4
    s_nop 1
    v_cndmask_b32 v149, 0, v2, vcc
    v_cmp_eq_u32 vcc, 2, v4
    s_nop 1
    v_cndmask_b32 v150, 0, v2, vcc
    v_cmp_eq_u32 vcc, 3, v4
    s_nop 1
    v_cndmask_b32 v151, 0, v2, vcc
    s_waitcnt lgkmcnt(0)
    v_lshlrev_b32 v11, 16, v64
    s_mov_b64 exec, 1
    ds_write_b32 v25, v11 offset:4188
    s_mov_b64 exec, -1
    v_alignbit_b32 v64, v65, v64, 16
    v_alignbit_b32 v65, v66, v65, 16
    v_alignbit_b32 v66, v67, v66, 16
    v_alignbit_b32 v67, v68, v67, 16
    ds_write_b128 v25, v[64:67] offset:4192
    v_alignbit_b32 v70, v71, v70, 16
    v_alignbit_b32 v71, v72, v71, 16
    v_alignbit_b32 v72, v73, v72, 16
    v_alignbit_b32 v73, v74, v73, 16
    ds_write_b128 v25, v[70:73] offset:5216
    v_alignbit_b32 v76, v77, v76, 16
    v_alignbit_b32 v77, v78, v77, 16
    v_alignbit_b32 v78, v79, v78, 16
    v_alignbit_b32 v79, v80, v79, 16
    ds_write_b128 v25, v[76:79] offset:6240
    v_alignbit_b32 v82, v83, v82, 16
    v_alignbit_b32 v83, v84, v83, 16
    v_alignbit_b32 v84, v85, v84, 16
    v_alignbit_b32 v85, v86, v85, 16
    ds_write_b128 v25, v[82:85] offset:7264
    s_lshl_b32 s82, s66, 12
    s_add_u32 s82, s82, 11534336
    s_lshl_b32 s70, s59, 2
    s_add_u32 s70, s70, 119744
    v_mov_b32 v2, s70
    v_mov_b32 v3, s60
    s_waitcnt vmcnt(0) lgkmcnt(0)
    v_add_u32 v2, 110592, v13
    ds_read_b128 v[224:227], v2 offset:0
    ds_read_b128 v[228:231], v2 offset:1024
    ds_read_b128 v[232:235], v2 offset:2048
    ds_read_b128 v[236:239], v2 offset:3072
    ds_read_b128 v[240:243], v2 offset:4096
    ds_read_b128 v[244:247], v2 offset:5120
    ds_read_b128 v[248:251], v2 offset:6144
    ds_read_b128 v[252:255], v2 offset:7168
    ds_read_b128 v[32:35], v30 offset:3584
    ds_read_b128 v[36:39], v30 offset:3072
    ds_read_b128 v[40:43], v30 offset:2560
    ds_read_b128 v[44:47], v30 offset:2048
    ds_read_b128 v[48:51], v30 offset:1536
    ds_read_b128 v[52:55], v30 offset:1024
    ds_read_b128 v[56:59], v30 offset:512
    ds_read_b128 v[60:63], v30 offset:0
    ds_read2_b32 v[128:129], v26 offset0:0 offset1:1
    ds_read2_b32 v[130:131], v26 offset0:2 offset1:3
    ds_read2_b32 v[132:133], v29 offset0:128 offset1:129
    ds_read2_b32 v[134:135], v29 offset0:130 offset1:131
    ds_read2_b32 v[136:137], v26 offset0:128 offset1:129
    ds_read2_b32 v[138:139], v26 offset0:130 offset1:131
    s_waitcnt lgkmcnt(13)
    v_mfma_f32_16x16x32_bf16 v[96:99], v[148:151], v[32:35], 0
    s_waitcnt lgkmcnt(12)
    v_mfma_f32_16x16x32_bf16 v[100:103], v[148:151], v[36:39], 0
    s_waitcnt lgkmcnt(11)
    v_mfma_f32_16x16x32_bf16 v[104:107], v[148:151], v[40:43], 0
    s_waitcnt lgkmcnt(10)
    v_mfma_f32_16x16x32_bf16 v[108:111], v[148:151], v[44:47], 0
    s_waitcnt lgkmcnt(9)
    v_mfma_f32_16x16x32_bf16 v[112:115], v[148:151], v[48:51], 0
    s_waitcnt lgkmcnt(8)
    v_mfma_f32_16x16x32_bf16 v[116:119], v[148:151], v[52:55], 0
    s_waitcnt lgkmcnt(7)
    v_mfma_f32_16x16x32_bf16 v[120:123], v[148:151], v[56:59], 0
    s_waitcnt lgkmcnt(6)
    v_mfma_f32_16x16x32_bf16 v[124:127], v[148:151], v[60:63], 0
    ds_read2_b32 v[140:141], v29 offset0:0 offset1:1
    ds_read2_b32 v[142:143], v29 offset0:2 offset1:3
    s_waitcnt lgkmcnt(6)
    v_mfma_f32_16x16x32_bf16 v[96:99], v[128:131], v[32:35], v[96:99]
    ds_read2_b32 v[144:145], v27 offset0:0 offset1:1
    v_mfma_f32_16x16x32_bf16 v[100:103], v[128:131], v[36:39], v[100:103]
    ds_read2_b32 v[146:147], v27 offset0:2 offset1:3
    v_mfma_f32_16x16x32_bf16 v[104:107], v[128:131], v[40:43], v[104:107]
    ds_read_b128 v[64:67], v30 offset:3648
    v_mfma_f32_16x16x32_bf16 v[108:111], v[128:131], v[44:47], v[108:111]
    ds_read_b128 v[68:71], v30 offset:3136
    v_mfma_f32_16x16x32_bf16 v[112:115], v[128:131], v[48:51], v[112:115]
    s_mul_i32 s30, s62, 81920
    s_add_u32 s30, s30, s7
    v_mfma_f32_16x16x32_bf16 v[116:119], v[128:131], v[52:55], v[116:119]
    s_add_u32 s31, s30, 40960
    v_subrev_u32 v2, 256, v0
    v_mfma_f32_16x16x32_bf16 v[120:123], v[128:131], v[56:59], v[120:123]
    v_mul_u32_u24 v3, 205, v2
    v_mfma_f32_16x16x32_bf16 v[124:127], v[128:131], v[60:63], v[124:127]
    v_lshrrev_b32 v3, 11, v3
    s_waitcnt lgkmcnt(8)
    v_mfma_f32_16x16x32_bf16 v[124:127], v[132:135], v[32:35], v[124:127]
    ds_read2_b32 v[128:129], v28 offset0:128 offset1:129
    ds_read2_b32 v[130:131], v28 offset0:130 offset1:131
    s_waitcnt lgkmcnt(8)
    v_mfma_f32_16x16x32_bf16 v[100:103], v[136:139], v[32:35], v[100:103]
    ds_read2_b32 v[132:133], v27 offset0:128 offset1:129
    v_mfma_f32_16x16x32_bf16 v[104:107], v[136:139], v[36:39], v[104:107]
    ds_read2_b32 v[134:135], v27 offset0:130 offset1:131
    v_mfma_f32_16x16x32_bf16 v[108:111], v[136:139], v[40:43], v[108:111]
    ds_read_b128 v[72:75], v30 offset:2624
    v_mfma_f32_16x16x32_bf16 v[112:115], v[136:139], v[44:47], v[112:115]
    ds_read_b128 v[76:79], v30 offset:2112
    v_mfma_f32_16x16x32_bf16 v[116:119], v[136:139], v[48:51], v[116:119]
    v_mul_u32_u24 v3, 1120, v3
    v_mfma_f32_16x16x32_bf16 v[120:123], v[136:139], v[52:55], v[120:123]
    v_lshl_add_u32 v174, v2, 4, v3
    v_mfma_f32_16x16x32_bf16 v[124:127], v[136:139], v[56:59], v[124:127]
    s_and_b32 s70, s59, 1
    s_mul_i32 s70, s70, 320
    s_waitcnt lgkmcnt(10)
    v_mfma_f32_16x16x32_bf16 v[120:123], v[140:143], v[32:35], v[120:123]
    ds_read2_b32 v[136:137], v28 offset0:0 offset1:1
    v_mfma_f32_16x16x32_bf16 v[124:127], v[140:143], v[36:39], v[124:127]
    ds_read2_b32 v[138:139], v28 offset0:2 offset1:3
    s_waitcnt lgkmcnt(10)
    v_mfma_f32_16x16x32_bf16 v[104:107], v[144:147], v[32:35], v[104:107]
    ds_read2_b32 v[140:141], v26 offset0:16 offset1:17
    v_mfma_f32_16x16x32_bf16 v[108:111], v[144:147], v[36:39], v[108:111]
    ds_read2_b32 v[142:143], v26 offset0:18 offset1:19
    v_mfma_f32_16x16x32_bf16 v[112:115], v[144:147], v[40:43], v[112:115]
    ds_read_b128 v[80:83], v30 offset:1600
    v_mfma_f32_16x16x32_bf16 v[116:119], v[144:147], v[44:47], v[116:119]
    ds_read_b128 v[84:87], v30 offset:1088
    v_mfma_f32_16x16x32_bf16 v[120:123], v[144:147], v[48:51], v[120:123]
    s_add_u32 s70, s70, 256
    v_add_u32 v2, s70, v1
    v_mfma_f32_16x16x32_bf16 v[124:127], v[144:147], v[52:55], v[124:127]
    v_mul_u32_u24 v3, 205, v2
    s_waitcnt lgkmcnt(10)
    v_mfma_f32_16x16x32_bf16 v[116:119], v[128:131], v[32:35], v[116:119]
    ds_read2_b32 v[144:145], v29 offset0:144 offset1:145
    v_mfma_f32_16x16x32_bf16 v[120:123], v[128:131], v[36:39], v[120:123]
    ds_read2_b32 v[146:147], v29 offset0:146 offset1:147
    v_mfma_f32_16x16x32_bf16 v[124:127], v[128:131], v[40:43], v[124:127]
    v_lshrrev_b32 v3, 11, v3
    s_waitcnt lgkmcnt(10)
    v_mfma_f32_16x16x32_bf16 v[108:111], v[132:135], v[32:35], v[108:111]
    ds_read2_b32 v[128:129], v26 offset0:144 offset1:145
    v_mfma_f32_16x16x32_bf16 v[112:115], v[132:135], v[36:39], v[112:115]
    ds_read2_b32 v[130:131], v26 offset0:146 offset1:147
    v_mfma_f32_16x16x32_bf16 v[116:119], v[132:135], v[40:43], v[116:119]
    ds_read_b128 v[88:91], v30 offset:576
    v_mfma_f32_16x16x32_bf16 v[120:123], v[132:135], v[44:47], v[120:123]
    ds_read_b128 v[92:95], v30 offset:64
    v_mfma_f32_16x16x32_bf16 v[124:127], v[132:135], v[48:51], v[124:127]
    v_mul_u32_u24 v3, 1120, v3
    s_waitcnt lgkmcnt(10)
    v_mfma_f32_16x16x32_bf16 v[112:115], v[136:139], v[32:35], v[112:115]
    ds_read2_b32 v[132:133], v29 offset0:16 offset1:17
    v_mfma_f32_16x16x32_bf16 v[116:119], v[136:139], v[36:39], v[116:119]
    ds_read2_b32 v[134:135], v29 offset0:18 offset1:19
    v_mfma_f32_16x16x32_bf16 v[120:123], v[136:139], v[40:43], v[120:123]
    v_lshl_add_u32 v175, v2, 4, v3
    v_mfma_f32_16x16x32_bf16 v[124:127], v[136:139], v[44:47], v[124:127]
    s_cmp_ge_u32 s59, 2
    s_cselect_b32 s72, 15, 23
    s_waitcnt lgkmcnt(2)
    v_mfma_f32_16x16x32_bf16 v[96:99], v[140:143], v[64:67], v[96:99]
    ds_read2_b32 v[136:137], v27 offset0:16 offset1:17
    v_mfma_f32_16x16x32_bf16 v[100:103], v[140:143], v[68:71], v[100:103]
    ds_read2_b32 v[138:139], v27 offset0:18 offset1:19
    v_mfma_f32_16x16x32_bf16 v[104:107], v[140:143], v[72:75], v[104:107]
    ds_read_b128 v[32:35], v30 offset:3712
    v_mfma_f32_16x16x32_bf16 v[108:111], v[140:143], v[76:79], v[108:111]
    ds_read_b128 v[36:39], v30 offset:3200
    v_mfma_f32_16x16x32_bf16 v[112:115], v[140:143], v[80:83], v[112:115]
    v_min_u32 v2, s72, v1
    v_mfma_f32_16x16x32_bf16 v[116:119], v[140:143], v[84:87], v[116:119]
    v_lshrrev_b32 v3, 3, v2
    v_mfma_f32_16x16x32_bf16 v[120:123], v[140:143], v[88:91], v[120:123]
    v_and_b32 v2, 7, v2
    v_mfma_f32_16x16x32_bf16 v[124:127], v[140:143], v[92:95], v[124:127]
    v_lshl_add_u32 v2, v3, 5, v2
    v_mfma_f32_16x16x32_bf16 v[124:127], v[144:147], v[64:67], v[124:127]
    ds_read2_b32 v[140:141], v28 offset0:144 offset1:145
    ds_read2_b32 v[142:143], v28 offset0:146 offset1:147
    v_mfma_f32_16x16x32_bf16 v[100:103], v[128:131], v[64:67], v[100:103]
    ds_read2_b32 v[144:145], v27 offset0:144 offset1:145
    v_mfma_f32_16x16x32_bf16 v[104:107], v[128:131], v[68:71], v[104:107]
    ds_read2_b32 v[146:147], v27 offset0:146 offset1:147
    v_mfma_f32_16x16x32_bf16 v[108:111], v[128:131], v[72:75], v[108:111]
    ds_read_b128 v[40:43], v30 offset:2688
    v_mfma_f32_16x16x32_bf16 v[112:115], v[128:131], v[76:79], v[112:115]
    ds_read_b128 v[44:47], v30 offset:2176
    v_mfma_f32_16x16x32_bf16 v[116:119], v[128:131], v[80:83], v[116:119]
    s_mul_i32 s70, s63, 80
    s_lshl3_add_u32 s70, s59, s70
    v_mfma_f32_16x16x32_bf16 v[120:123], v[128:131], v[84:87], v[120:123]
    v_add_u32 v2, s70, v2
    v_mfma_f32_16x16x32_bf16 v[124:127], v[128:131], v[88:91], v[124:127]
    v_mul_u32_u24 v2, 128, v2
    s_waitcnt lgkmcnt(10)
    v_mfma_f32_16x16x32_bf16 v[120:123], v[132:135], v[64:67], v[120:123]
    ds_read2_b32 v[128:129], v28 offset0:16 offset1:17
    v_mfma_f32_16x16x32_bf16 v[124:127], v[132:135], v[68:71], v[124:127]
    ds_read2_b32 v[130:131], v28 offset0:18 offset1:19
    s_waitcnt lgkmcnt(10)
    v_mfma_f32_16x16x32_bf16 v[104:107], v[136:139], v[64:67], v[104:107]
    ds_read2_b32 v[132:133], v26 offset0:32 offset1:33
    v_mfma_f32_16x16x32_bf16 v[108:111], v[136:139], v[68:71], v[108:111]
    ds_read2_b32 v[134:135], v26 offset0:34 offset1:35
    v_mfma_f32_16x16x32_bf16 v[112:115], v[136:139], v[72:75], v[112:115]
    ds_read_b128 v[48:51], v30 offset:1664
    v_mfma_f32_16x16x32_bf16 v[116:119], v[136:139], v[76:79], v[116:119]
    ds_read_b128 v[52:55], v30 offset:1152
    v_mfma_f32_16x16x32_bf16 v[120:123], v[136:139], v[80:83], v[120:123]
    v_add_u32 v170, 18350080, v2
    v_mfma_f32_16x16x32_bf16 v[124:127], v[136:139], v[84:87], v[124:127]
    s_mul_i32 s70, s66, 128
    s_add_u32 s70, s70, 18350080
    s_waitcnt lgkmcnt(10)
    v_mfma_f32_16x16x32_bf16 v[116:119], v[140:143], v[64:67], v[116:119]
    ds_read2_b32 v[136:137], v29 offset0:160 offset1:161
    v_mfma_f32_16x16x32_bf16 v[120:123], v[140:143], v[68:71], v[120:123]
    ds_read2_b32 v[138:139], v29 offset0:162 offset1:163
    v_mfma_f32_16x16x32_bf16 v[124:127], v[140:143], v[72:75], v[124:127]
    v_mov_b32 v171, s70
    s_waitcnt lgkmcnt(10)
    v_mfma_f32_16x16x32_bf16 v[108:111], v[144:147], v[64:67], v[108:111]
    ds_read2_b32 v[140:141], v26 offset0:160 offset1:161
    v_mfma_f32_16x16x32_bf16 v[112:115], v[144:147], v[68:71], v[112:115]
    ds_read2_b32 v[142:143], v26 offset0:162 offset1:163
    v_mfma_f32_16x16x32_bf16 v[116:119], v[144:147], v[72:75], v[116:119]
    ds_read_b128 v[56:59], v30 offset:640
    v_mfma_f32_16x16x32_bf16 v[120:123], v[144:147], v[76:79], v[120:123]
    ds_read_b128 v[60:63], v30 offset:128
    v_mfma_f32_16x16x32_bf16 v[124:127], v[144:147], v[80:83], v[124:127]
    s_lshl_b32 s70, s56, 9
    v_and_b32 v2, 31, v1
    s_waitcnt lgkmcnt(10)
    v_mfma_f32_16x16x32_bf16 v[112:115], v[128:131], v[64:67], v[112:115]
    ds_read2_b32 v[144:145], v29 offset0:32 offset1:33
    v_mfma_f32_16x16x32_bf16 v[116:119], v[128:131], v[68:71], v[116:119]
    ds_read2_b32 v[146:147], v29 offset0:34 offset1:35
    v_mfma_f32_16x16x32_bf16 v[120:123], v[128:131], v[72:75], v[120:123]
    v_lshrrev_b32 v3, 5, v1
    v_mfma_f32_16x16x32_bf16 v[124:127], v[128:131], v[76:79], v[124:127]
    v_lshlrev_b32 v206, 3, v2
    s_waitcnt lgkmcnt(2)
    v_mfma_f32_16x16x32_bf16 v[96:99], v[132:135], v[32:35], v[96:99]
    ds_read2_b32 v[128:129], v27 offset0:32 offset1:33
    v_mfma_f32_16x16x32_bf16 v[100:103], v[132:135], v[36:39], v[100:103]
    ds_read2_b32 v[130:131], v27 offset0:34 offset1:35
    v_mfma_f32_16x16x32_bf16 v[104:107], v[132:135], v[40:43], v[104:107]
    ds_read_b128 v[64:67], v30 offset:3776
    v_mfma_f32_16x16x32_bf16 v[108:111], v[132:135], v[44:47], v[108:111]
    ds_read_b128 v[68:71], v30 offset:3264
    v_mfma_f32_16x16x32_bf16 v[112:115], v[132:135], v[48:51], v[112:115]
    v_lshlrev_b32 v4, 4, v2
    v_mfma_f32_16x16x32_bf16 v[116:119], v[132:135], v[52:55], v[116:119]
    v_lshl_add_u32 v205, v3, 15, v4
    v_mfma_f32_16x16x32_bf16 v[120:123], v[132:135], v[56:59], v[120:123]
    v_add_u32 v4, s70, v4
    v_mfma_f32_16x16x32_bf16 v[124:127], v[132:135], v[60:63], v[124:127]
    v_lshl_add_u32 v5, v3, 12, v4
    v_mfma_f32_16x16x32_bf16 v[124:127], v[136:139], v[32:35], v[124:127]
    ds_read2_b32 v[132:133], v28 offset0:160 offset1:161
    ds_read2_b32 v[134:135], v28 offset0:162 offset1:163
    v_mfma_f32_16x16x32_bf16 v[100:103], v[140:143], v[32:35], v[100:103]
    ds_read2_b32 v[136:137], v27 offset0:160 offset1:161
    v_mfma_f32_16x16x32_bf16 v[104:107], v[140:143], v[36:39], v[104:107]
    ds_read2_b32 v[138:139], v27 offset0:162 offset1:163
    v_mfma_f32_16x16x32_bf16 v[108:111], v[140:143], v[40:43], v[108:111]
    ds_read_b128 v[72:75], v30 offset:2752
    v_mfma_f32_16x16x32_bf16 v[112:115], v[140:143], v[44:47], v[112:115]
    ds_read_b128 v[76:79], v30 offset:2240
    v_mfma_f32_16x16x32_bf16 v[116:119], v[140:143], v[48:51], v[116:119]
    v_add_u32 v201, 83712, v5
    v_mfma_f32_16x16x32_bf16 v[120:123], v[140:143], v[52:55], v[120:123]
    v_add_u32 v202, 91904, v4
    v_mfma_f32_16x16x32_bf16 v[124:127], v[140:143], v[56:59], v[124:127]
    v_lshl_add_u32 v197, v3, 13, v4
    s_waitcnt lgkmcnt(10)
    v_mfma_f32_16x16x32_bf16 v[120:123], v[144:147], v[32:35], v[120:123]
    ds_read2_b32 v[140:141], v28 offset0:32 offset1:33
    v_mfma_f32_16x16x32_bf16 v[124:127], v[144:147], v[36:39], v[124:127]
    ds_read2_b32 v[142:143], v28 offset0:34 offset1:35
    s_waitcnt lgkmcnt(10)
    v_mfma_f32_16x16x32_bf16 v[104:107], v[128:131], v[32:35], v[104:107]
    ds_read2_b32 v[144:145], v26 offset0:48 offset1:49
    v_mfma_f32_16x16x32_bf16 v[108:111], v[128:131], v[36:39], v[108:111]
    ds_read2_b32 v[146:147], v26 offset0:50 offset1:51
    v_mfma_f32_16x16x32_bf16 v[112:115], v[128:131], v[40:43], v[112:115]
    ds_read_b128 v[80:83], v30 offset:1728
    v_mfma_f32_16x16x32_bf16 v[116:119], v[128:131], v[44:47], v[116:119]
    ds_read_b128 v[84:87], v30 offset:1216
    v_mfma_f32_16x16x32_bf16 v[120:123], v[128:131], v[48:51], v[120:123]
    v_add_u32 v197, 59136, v197
    v_mfma_f32_16x16x32_bf16 v[124:127], v[128:131], v[52:55], v[124:127]
    v_lshlrev_b32 v5, 9, v3
    s_waitcnt lgkmcnt(10)
    v_mfma_f32_16x16x32_bf16 v[116:119], v[132:135], v[32:35], v[116:119]
    ds_read2_b32 v[128:129], v29 offset0:176 offset1:177
    v_mfma_f32_16x16x32_bf16 v[120:123], v[132:135], v[36:39], v[120:123]
    ds_read2_b32 v[130:131], v29 offset0:178 offset1:179
    v_mfma_f32_16x16x32_bf16 v[124:127], v[132:135], v[40:43], v[124:127]
    v_sub_u32 v5, v4, v5
    s_waitcnt lgkmcnt(10)
    v_mfma_f32_16x16x32_bf16 v[108:111], v[136:139], v[32:35], v[108:111]
    ds_read2_b32 v[132:133], v26 offset0:176 offset1:177
    v_mfma_f32_16x16x32_bf16 v[112:115], v[136:139], v[36:39], v[112:115]
    ds_read2_b32 v[134:135], v26 offset0:178 offset1:179
    v_mfma_f32_16x16x32_bf16 v[116:119], v[136:139], v[40:43], v[116:119]
    ds_read_b128 v[88:91], v30 offset:704
    v_mfma_f32_16x16x32_bf16 v[120:123], v[136:139], v[44:47], v[120:123]
    ds_read_b128 v[92:95], v30 offset:192
    v_mfma_f32_16x16x32_bf16 v[124:127], v[136:139], v[48:51], v[124:127]
    v_add_u32 v198, 75520, v5
    s_waitcnt lgkmcnt(10)
    v_mfma_f32_16x16x32_bf16 v[112:115], v[140:143], v[32:35], v[112:115]
    ds_read2_b32 v[136:137], v29 offset0:48 offset1:49
    v_mfma_f32_16x16x32_bf16 v[116:119], v[140:143], v[36:39], v[116:119]
    ds_read2_b32 v[138:139], v29 offset0:50 offset1:51
    v_mfma_f32_16x16x32_bf16 v[120:123], v[140:143], v[40:43], v[120:123]
    v_bfe_u32 v4, v1, 2, 2
    v_mfma_f32_16x16x32_bf16 v[124:127], v[140:143], v[44:47], v[124:127]
    v_lshl_add_u32 v4, v3, 2, v4
    s_waitcnt lgkmcnt(2)
    v_mfma_f32_16x16x32_bf16 v[96:99], v[144:147], v[64:67], v[96:99]
    ds_read2_b32 v[140:141], v27 offset0:48 offset1:49
    v_mfma_f32_16x16x32_bf16 v[100:103], v[144:147], v[68:71], v[100:103]
    ds_read2_b32 v[142:143], v27 offset0:50 offset1:51
    v_mfma_f32_16x16x32_bf16 v[104:107], v[144:147], v[72:75], v[104:107]
    ds_read_b128 v[32:35], v30 offset:3840
    v_mfma_f32_16x16x32_bf16 v[108:111], v[144:147], v[76:79], v[108:111]
    ds_read_b128 v[36:39], v30 offset:3328
    v_mfma_f32_16x16x32_bf16 v[112:115], v[144:147], v[80:83], v[112:115]
    v_lshlrev_b32 v4, 4, v4
    v_mfma_f32_16x16x32_bf16 v[116:119], v[144:147], v[84:87], v[116:119]
    v_bfe_u32 v5, v1, 1, 1
    v_mfma_f32_16x16x32_bf16 v[120:123], v[144:147], v[88:91], v[120:123]
    v_mul_u32_u24 v5, 8256, v5
    v_mfma_f32_16x16x32_bf16 v[124:127], v[144:147], v[92:95], v[124:127]
    v_and_b32 v6, 1, v1
    v_mfma_f32_16x16x32_bf16 v[124:127], v[128:131], v[64:67], v[124:127]
    ds_read2_b32 v[144:145], v28 offset0:176 offset1:177
    ds_read2_b32 v[146:147], v28 offset0:178 offset1:179
    v_mfma_f32_16x16x32_bf16 v[100:103], v[132:135], v[64:67], v[100:103]
    ds_read2_b32 v[128:129], v27 offset0:176 offset1:177
    v_mfma_f32_16x16x32_bf16 v[104:107], v[132:135], v[68:71], v[104:107]
    ds_read2_b32 v[130:131], v27 offset0:178 offset1:179
    v_mfma_f32_16x16x32_bf16 v[108:111], v[132:135], v[72:75], v[108:111]
    ds_read_b128 v[40:43], v30 offset:2816
    v_mfma_f32_16x16x32_bf16 v[112:115], v[132:135], v[76:79], v[112:115]
    ds_read_b128 v[44:47], v30 offset:2304
    v_mfma_f32_16x16x32_bf16 v[116:119], v[132:135], v[80:83], v[116:119]
    v_lshl_add_u32 v5, v6, 3, v5
    v_mfma_f32_16x16x32_bf16 v[120:123], v[132:135], v[84:87], v[120:123]
    s_and_b32 s71, s68, 1
    s_lshl_b32 s72, s71, 3
    v_mfma_f32_16x16x32_bf16 v[124:127], v[132:135], v[88:91], v[124:127]
    s_add_u32 s72, s72, 16512
    v_mov_b32 v6, s72
    s_waitcnt lgkmcnt(10)
    v_mfma_f32_16x16x32_bf16 v[120:123], v[136:139], v[64:67], v[120:123]
    ds_read2_b32 v[132:133], v28 offset0:48 offset1:49
    v_mfma_f32_16x16x32_bf16 v[124:127], v[136:139], v[68:71], v[124:127]
    ds_read2_b32 v[134:135], v28 offset0:50 offset1:51
    s_waitcnt lgkmcnt(10)
    v_mfma_f32_16x16x32_bf16 v[104:107], v[140:143], v[64:67], v[104:107]
    ds_read2_b32 v[136:137], v26 offset0:64 offset1:65
    v_mfma_f32_16x16x32_bf16 v[108:111], v[140:143], v[68:71], v[108:111]
    ds_read2_b32 v[138:139], v26 offset0:66 offset1:67
    v_mfma_f32_16x16x32_bf16 v[112:115], v[140:143], v[72:75], v[112:115]
    ds_read_b128 v[48:51], v30 offset:1792
    v_mfma_f32_16x16x32_bf16 v[116:119], v[140:143], v[76:79], v[116:119]
    ds_read_b128 v[52:55], v30 offset:1280
    v_mfma_f32_16x16x32_bf16 v[120:123], v[140:143], v[80:83], v[120:123]
    v_and_b32 v7, 16, v1
    v_mfma_f32_16x16x32_bf16 v[124:127], v[140:143], v[84:87], v[124:127]
    v_cmp_ne_u32 vcc, 0, v7
    s_waitcnt lgkmcnt(10)
    v_mfma_f32_16x16x32_bf16 v[116:119], v[144:147], v[64:67], v[116:119]
    ds_read2_b32 v[140:141], v29 offset0:192 offset1:193
    v_mfma_f32_16x16x32_bf16 v[120:123], v[144:147], v[68:71], v[120:123]
    ds_read2_b32 v[142:143], v29 offset0:194 offset1:195
    v_mfma_f32_16x16x32_bf16 v[124:127], v[144:147], v[72:75], v[124:127]
    v_cndmask_b32 v5, v5, v6, vcc
    s_waitcnt lgkmcnt(10)
    v_mfma_f32_16x16x32_bf16 v[108:111], v[128:131], v[64:67], v[108:111]
    ds_read2_b32 v[144:145], v26 offset0:192 offset1:193
    v_mfma_f32_16x16x32_bf16 v[112:115], v[128:131], v[68:71], v[112:115]
    ds_read2_b32 v[146:147], v26 offset0:194 offset1:195
    v_mfma_f32_16x16x32_bf16 v[116:119], v[128:131], v[72:75], v[116:119]
    ds_read_b128 v[56:59], v30 offset:768
    v_mfma_f32_16x16x32_bf16 v[120:123], v[128:131], v[76:79], v[120:123]
    ds_read_b128 v[60:63], v30 offset:256
    v_mfma_f32_16x16x32_bf16 v[124:127], v[128:131], v[80:83], v[124:127]
    s_add_u32 s70, s70, 36352
    v_add3_u32 v5, v5, v4, s70
    s_waitcnt lgkmcnt(10)
    v_mfma_f32_16x16x32_bf16 v[112:115], v[132:135], v[64:67], v[112:115]
    ds_read2_b32 v[128:129], v29 offset0:64 offset1:65
    v_mfma_f32_16x16x32_bf16 v[116:119], v[132:135], v[68:71], v[116:119]
    ds_read2_b32 v[130:131], v29 offset0:66 offset1:67
    v_mfma_f32_16x16x32_bf16 v[120:123], v[132:135], v[72:75], v[120:123]
    v_and_b32 v7, 2, v1
    v_mfma_f32_16x16x32_bf16 v[124:127], v[132:135], v[76:79], v[124:127]
    v_sub_u32 v7, 2, v7
    s_waitcnt lgkmcnt(2)
    v_mfma_f32_16x16x32_bf16 v[96:99], v[136:139], v[32:35], v[96:99]
    ds_read2_b32 v[132:133], v27 offset0:64 offset1:65
    v_mfma_f32_16x16x32_bf16 v[100:103], v[136:139], v[36:39], v[100:103]
    ds_read2_b32 v[134:135], v27 offset0:66 offset1:67
    v_mfma_f32_16x16x32_bf16 v[104:107], v[136:139], v[40:43], v[104:107]
    ds_read_b128 v[64:67], v30 offset:3904
    v_mfma_f32_16x16x32_bf16 v[108:111], v[136:139], v[44:47], v[108:111]
    ds_read_b128 v[68:71], v30 offset:3392
    v_mfma_f32_16x16x32_bf16 v[112:115], v[136:139], v[48:51], v[112:115]
    v_lshl_add_u32 v4, v7, 2, v4
    v_mfma_f32_16x16x32_bf16 v[116:119], v[136:139], v[52:55], v[116:119]
    v_and_b32 v7, 19, v1
    v_mfma_f32_16x16x32_bf16 v[120:123], v[136:139], v[56:59], v[120:123]
    v_cmp_lt_u32 vcc, 16, v7
    v_mfma_f32_16x16x32_bf16 v[124:127], v[136:139], v[60:63], v[124:127]
    s_add_u32 s70, s56, 1
    s_cmp_eq_u32 s69, 0
    v_mfma_f32_16x16x32_bf16 v[124:127], v[140:143], v[32:35], v[124:127]
    ds_read2_b32 v[136:137], v28 offset0:192 offset1:193
    ds_read2_b32 v[138:139], v28 offset0:194 offset1:195
    v_mfma_f32_16x16x32_bf16 v[100:103], v[144:147], v[32:35], v[100:103]
    ds_read2_b32 v[140:141], v27 offset0:192 offset1:193
    v_mfma_f32_16x16x32_bf16 v[104:107], v[144:147], v[36:39], v[104:107]
    ds_read2_b32 v[142:143], v27 offset0:194 offset1:195
    v_mfma_f32_16x16x32_bf16 v[108:111], v[144:147], v[40:43], v[108:111]
    ds_read_b128 v[72:75], v30 offset:2880
    v_mfma_f32_16x16x32_bf16 v[112:115], v[144:147], v[44:47], v[112:115]
    ds_read_b128 v[76:79], v30 offset:2368
    v_mfma_f32_16x16x32_bf16 v[116:119], v[144:147], v[48:51], v[116:119]
    s_cselect_b32 s77, s70, 99
    s_cmp_gt_u32 s77, 0
    v_mfma_f32_16x16x32_bf16 v[120:123], v[144:147], v[52:55], v[120:123]
    s_cselect_b32 s70, 24576, 0
    s_add_u32 s70, s70, 32960
    v_mfma_f32_16x16x32_bf16 v[124:127], v[144:147], v[56:59], v[124:127]
    s_cmp_gt_u32 s77, 1
    s_cselect_b32 s70, 58048, s70
    s_waitcnt lgkmcnt(10)
    v_mfma_f32_16x16x32_bf16 v[120:123], v[128:131], v[32:35], v[120:123]
    ds_read2_b32 v[144:145], v28 offset0:64 offset1:65
    v_mfma_f32_16x16x32_bf16 v[124:127], v[128:131], v[36:39], v[124:127]
    ds_read2_b32 v[146:147], v28 offset0:66 offset1:67
    s_waitcnt lgkmcnt(10)
    v_mfma_f32_16x16x32_bf16 v[104:107], v[132:135], v[32:35], v[104:107]
    ds_read2_b32 v[128:129], v26 offset0:80 offset1:81
    v_mfma_f32_16x16x32_bf16 v[108:111], v[132:135], v[36:39], v[108:111]
    ds_read2_b32 v[130:131], v26 offset0:82 offset1:83
    v_mfma_f32_16x16x32_bf16 v[112:115], v[132:135], v[40:43], v[112:115]
    ds_read_b128 v[80:83], v30 offset:1856
    v_mfma_f32_16x16x32_bf16 v[116:119], v[132:135], v[44:47], v[116:119]
    ds_read_b128 v[84:87], v30 offset:1344
    v_mfma_f32_16x16x32_bf16 v[120:123], v[132:135], v[48:51], v[120:123]
    v_add_u32 v6, s70, v4
    v_mfma_f32_16x16x32_bf16 v[124:127], v[132:135], v[52:55], v[124:127]
    v_cndmask_b32 v190, v5, v6, vcc
    s_waitcnt lgkmcnt(10)
    v_mfma_f32_16x16x32_bf16 v[116:119], v[136:139], v[32:35], v[116:119]
    ds_read2_b32 v[132:133], v29 offset0:208 offset1:209
    v_mfma_f32_16x16x32_bf16 v[120:123], v[136:139], v[36:39], v[120:123]
    ds_read2_b32 v[134:135], v29 offset0:210 offset1:211
    v_mfma_f32_16x16x32_bf16 v[124:127], v[136:139], v[40:43], v[124:127]
    v_subrev_u32 v5, 1024, v5
    s_waitcnt lgkmcnt(10)
    v_mfma_f32_16x16x32_bf16 v[108:111], v[140:143], v[32:35], v[108:111]
    ds_read2_b32 v[136:137], v26 offset0:208 offset1:209
    v_mfma_f32_16x16x32_bf16 v[112:115], v[140:143], v[36:39], v[112:115]
    ds_read2_b32 v[138:139], v26 offset0:210 offset1:211
    v_mfma_f32_16x16x32_bf16 v[116:119], v[140:143], v[40:43], v[116:119]
    ds_read_b128 v[88:91], v30 offset:832
    v_mfma_f32_16x16x32_bf16 v[120:123], v[140:143], v[44:47], v[120:123]
    ds_read_b128 v[92:95], v30 offset:320
    v_mfma_f32_16x16x32_bf16 v[124:127], v[140:143], v[48:51], v[124:127]
    s_cmp_gt_u32 s77, 2
    s_cselect_b32 s70, 24576, 0
    s_waitcnt lgkmcnt(10)
    v_mfma_f32_16x16x32_bf16 v[112:115], v[144:147], v[32:35], v[112:115]
    ds_read2_b32 v[140:141], v29 offset0:80 offset1:81
    v_mfma_f32_16x16x32_bf16 v[116:119], v[144:147], v[36:39], v[116:119]
    ds_read2_b32 v[142:143], v29 offset0:82 offset1:83
    v_mfma_f32_16x16x32_bf16 v[120:123], v[144:147], v[40:43], v[120:123]
    s_add_u32 s70, s70, 32960
    s_cmp_gt_u32 s77, 3
    v_mfma_f32_16x16x32_bf16 v[124:127], v[144:147], v[44:47], v[124:127]
    s_cselect_b32 s70, 58048, s70
    v_add_u32 v6, s70, v4
    s_waitcnt lgkmcnt(2)
    v_mfma_f32_16x16x32_bf16 v[96:99], v[128:131], v[64:67], v[96:99]
    ds_read2_b32 v[144:145], v27 offset0:80 offset1:81
    v_mfma_f32_16x16x32_bf16 v[100:103], v[128:131], v[68:71], v[100:103]
    ds_read2_b32 v[146:147], v27 offset0:82 offset1:83
    v_mfma_f32_16x16x32_bf16 v[104:107], v[128:131], v[72:75], v[104:107]
    ds_read_b128 v[32:35], v30 offset:3968
    v_mfma_f32_16x16x32_bf16 v[108:111], v[128:131], v[76:79], v[108:111]
    ds_read_b128 v[36:39], v30 offset:3456
    v_mfma_f32_16x16x32_bf16 v[112:115], v[128:131], v[80:83], v[112:115]
    v_cndmask_b32 v191, v5, v6, vcc
    v_mfma_f32_16x16x32_bf16 v[116:119], v[128:131], v[84:87], v[116:119]
    v_subrev_u32 v5, 1024, v5
    v_mfma_f32_16x16x32_bf16 v[120:123], v[128:131], v[88:91], v[120:123]
    s_cmp_gt_u32 s77, 4
    s_cselect_b32 s70, 24576, 0
    v_mfma_f32_16x16x32_bf16 v[124:127], v[128:131], v[92:95], v[124:127]
    s_add_u32 s70, s70, 32960
    s_cmp_gt_u32 s77, 5
    v_mfma_f32_16x16x32_bf16 v[124:127], v[132:135], v[64:67], v[124:127]
    ds_read2_b32 v[128:129], v28 offset0:208 offset1:209
    ds_read2_b32 v[130:131], v28 offset0:210 offset1:211
    v_mfma_f32_16x16x32_bf16 v[100:103], v[136:139], v[64:67], v[100:103]
    ds_read2_b32 v[132:133], v27 offset0:208 offset1:209
    v_mfma_f32_16x16x32_bf16 v[104:107], v[136:139], v[68:71], v[104:107]
    ds_read2_b32 v[134:135], v27 offset0:210 offset1:211
    v_mfma_f32_16x16x32_bf16 v[108:111], v[136:139], v[72:75], v[108:111]
    ds_read_b128 v[40:43], v30 offset:2944
    v_mfma_f32_16x16x32_bf16 v[112:115], v[136:139], v[76:79], v[112:115]
    ds_read_b128 v[44:47], v30 offset:2432
    v_mfma_f32_16x16x32_bf16 v[116:119], v[136:139], v[80:83], v[116:119]
    s_cselect_b32 s70, 58048, s70
    v_add_u32 v6, s70, v4
    v_mfma_f32_16x16x32_bf16 v[120:123], v[136:139], v[84:87], v[120:123]
    v_cndmask_b32 v192, v5, v6, vcc
    v_mfma_f32_16x16x32_bf16 v[124:127], v[136:139], v[88:91], v[124:127]
    v_subrev_u32 v5, 1024, v5
    s_waitcnt lgkmcnt(10)
    v_mfma_f32_16x16x32_bf16 v[120:123], v[140:143], v[64:67], v[120:123]
    ds_read2_b32 v[136:137], v28 offset0:80 offset1:81
    v_mfma_f32_16x16x32_bf16 v[124:127], v[140:143], v[68:71], v[124:127]
    ds_read2_b32 v[138:139], v28 offset0:82 offset1:83
    s_waitcnt lgkmcnt(10)
    v_mfma_f32_16x16x32_bf16 v[104:107], v[144:147], v[64:67], v[104:107]
    ds_read2_b32 v[140:141], v26 offset0:96 offset1:97
    v_mfma_f32_16x16x32_bf16 v[108:111], v[144:147], v[68:71], v[108:111]
    ds_read2_b32 v[142:143], v26 offset0:98 offset1:99
    v_mfma_f32_16x16x32_bf16 v[112:115], v[144:147], v[72:75], v[112:115]
    ds_read_b128 v[48:51], v30 offset:1920
    v_mfma_f32_16x16x32_bf16 v[116:119], v[144:147], v[76:79], v[116:119]
    ds_read_b128 v[52:55], v30 offset:1408
    v_mfma_f32_16x16x32_bf16 v[120:123], v[144:147], v[80:83], v[120:123]
    s_cmp_gt_u32 s77, 6
    s_cselect_b32 s70, 24576, 0
    v_mfma_f32_16x16x32_bf16 v[124:127], v[144:147], v[84:87], v[124:127]
    s_add_u32 s70, s70, 32960
    s_cmp_gt_u32 s77, 7
    s_waitcnt lgkmcnt(10)
    v_mfma_f32_16x16x32_bf16 v[116:119], v[128:131], v[64:67], v[116:119]
    ds_read2_b32 v[144:145], v29 offset0:224 offset1:225
    v_mfma_f32_16x16x32_bf16 v[120:123], v[128:131], v[68:71], v[120:123]
    ds_read2_b32 v[146:147], v29 offset0:226 offset1:227
    v_mfma_f32_16x16x32_bf16 v[124:127], v[128:131], v[72:75], v[124:127]
    s_cselect_b32 s70, 58048, s70
    v_add_u32 v6, s70, v4
    s_waitcnt lgkmcnt(10)
    v_mfma_f32_16x16x32_bf16 v[108:111], v[132:135], v[64:67], v[108:111]
    ds_read2_b32 v[128:129], v26 offset0:224 offset1:225
    v_mfma_f32_16x16x32_bf16 v[112:115], v[132:135], v[68:71], v[112:115]
    ds_read2_b32 v[130:131], v26 offset0:226 offset1:227
    v_mfma_f32_16x16x32_bf16 v[116:119], v[132:135], v[72:75], v[116:119]
    ds_read_b128 v[56:59], v30 offset:896
    v_mfma_f32_16x16x32_bf16 v[120:123], v[132:135], v[76:79], v[120:123]
    ds_read_b128 v[60:63], v30 offset:384
    v_mfma_f32_16x16x32_bf16 v[124:127], v[132:135], v[80:83], v[124:127]
    v_cndmask_b32 v193, v5, v6, vcc
    s_waitcnt lgkmcnt(10)
    v_mfma_f32_16x16x32_bf16 v[112:115], v[136:139], v[64:67], v[112:115]
    ds_read2_b32 v[132:133], v29 offset0:96 offset1:97
    v_mfma_f32_16x16x32_bf16 v[116:119], v[136:139], v[68:71], v[116:119]
    ds_read2_b32 v[134:135], v29 offset0:98 offset1:99
    v_mfma_f32_16x16x32_bf16 v[120:123], v[136:139], v[72:75], v[120:123]
    v_subrev_u32 v5, 1024, v5
    v_mfma_f32_16x16x32_bf16 v[124:127], v[136:139], v[76:79], v[124:127]
    s_cmp_gt_u32 s77, 8
    s_cselect_b32 s70, 24576, 0
    s_waitcnt lgkmcnt(2)
    v_mfma_f32_16x16x32_bf16 v[96:99], v[140:143], v[32:35], v[96:99]
    ds_read2_b32 v[136:137], v27 offset0:96 offset1:97
    v_mfma_f32_16x16x32_bf16 v[100:103], v[140:143], v[36:39], v[100:103]
    ds_read2_b32 v[138:139], v27 offset0:98 offset1:99
    v_mfma_f32_16x16x32_bf16 v[104:107], v[140:143], v[40:43], v[104:107]
    ds_read_b128 v[64:67], v30 offset:4032
    v_mfma_f32_16x16x32_bf16 v[108:111], v[140:143], v[44:47], v[108:111]
    ds_read_b128 v[68:71], v30 offset:3520
    v_mfma_f32_16x16x32_bf16 v[112:115], v[140:143], v[48:51], v[112:115]
    s_add_u32 s70, s70, 32960
    s_cmp_gt_u32 s77, 9
    v_mfma_f32_16x16x32_bf16 v[116:119], v[140:143], v[52:55], v[116:119]
    s_cselect_b32 s70, 58048, s70
    v_add_u32 v6, s70, v4
    v_mfma_f32_16x16x32_bf16 v[120:123], v[140:143], v[56:59], v[120:123]
    v_cndmask_b32 v194, v5, v6, vcc
    v_mfma_f32_16x16x32_bf16 v[124:127], v[140:143], v[60:63], v[124:127]
    v_subrev_u32 v5, 1024, v5
    v_mfma_f32_16x16x32_bf16 v[124:127], v[144:147], v[32:35], v[124:127]
    ds_read2_b32 v[140:141], v28 offset0:224 offset1:225
    ds_read2_b32 v[142:143], v28 offset0:226 offset1:227
    v_mfma_f32_16x16x32_bf16 v[100:103], v[128:131], v[32:35], v[100:103]
    ds_read2_b32 v[144:145], v27 offset0:224 offset1:225
    v_mfma_f32_16x16x32_bf16 v[104:107], v[128:131], v[36:39], v[104:107]
    ds_read2_b32 v[146:147], v27 offset0:226 offset1:227
    v_mfma_f32_16x16x32_bf16 v[108:111], v[128:131], v[40:43], v[108:111]
    ds_read_b128 v[72:75], v30 offset:3008
    v_mfma_f32_16x16x32_bf16 v[112:115], v[128:131], v[44:47], v[112:115]
    ds_read_b128 v[76:79], v30 offset:2496
    v_mfma_f32_16x16x32_bf16 v[116:119], v[128:131], v[48:51], v[116:119]
    s_mov_b32 s78, 0
    s_cmp_eq_u32 s71, 0
    v_mfma_f32_16x16x32_bf16 v[120:123], v[128:131], v[52:55], v[120:123]
    s_cselect_b32 s72, -1, 0
    s_cselect_b32 s73, 0, -1
    v_mfma_f32_16x16x32_bf16 v[124:127], v[128:131], v[56:59], v[124:127]
    v_cmp_eq_u32 vcc, 0, v3
    s_waitcnt lgkmcnt(10)
    v_mfma_f32_16x16x32_bf16 v[120:123], v[132:135], v[32:35], v[120:123]
    ds_read2_b32 v[128:129], v28 offset0:96 offset1:97
    v_mfma_f32_16x16x32_bf16 v[124:127], v[132:135], v[36:39], v[124:127]
    ds_read2_b32 v[130:131], v28 offset0:98 offset1:99
    s_waitcnt lgkmcnt(10)
    v_mfma_f32_16x16x32_bf16 v[104:107], v[136:139], v[32:35], v[104:107]
    ds_read2_b32 v[132:133], v29 offset0:240 offset1:241
    v_mfma_f32_16x16x32_bf16 v[108:111], v[136:139], v[36:39], v[108:111]
    ds_read2_b32 v[134:135], v29 offset0:242 offset1:243
    v_mfma_f32_16x16x32_bf16 v[112:115], v[136:139], v[40:43], v[112:115]
    ds_read_b128 v[80:83], v30 offset:1984
    v_mfma_f32_16x16x32_bf16 v[116:119], v[136:139], v[44:47], v[116:119]
    ds_read_b128 v[84:87], v30 offset:1472
    v_mfma_f32_16x16x32_bf16 v[120:123], v[136:139], v[48:51], v[120:123]
    v_mov_b32 v5, s72
    v_mfma_f32_16x16x32_bf16 v[124:127], v[136:139], v[52:55], v[124:127]
    v_mov_b32 v6, s73
    s_waitcnt lgkmcnt(10)
    v_mfma_f32_16x16x32_bf16 v[116:119], v[140:143], v[32:35], v[116:119]
    ds_read2_b32 v[136:137], v29 offset0:112 offset1:113
    v_mfma_f32_16x16x32_bf16 v[120:123], v[140:143], v[36:39], v[120:123]
    ds_read2_b32 v[138:139], v29 offset0:114 offset1:115
    v_mfma_f32_16x16x32_bf16 v[124:127], v[140:143], v[40:43], v[124:127]
    v_cndmask_b32 v203, 0, v5, vcc
    s_waitcnt lgkmcnt(10)
    v_mfma_f32_16x16x32_bf16 v[108:111], v[144:147], v[32:35], v[108:111]
    ds_read2_b32 v[140:141], v28 offset0:240 offset1:241
    v_mfma_f32_16x16x32_bf16 v[112:115], v[144:147], v[36:39], v[112:115]
    ds_read2_b32 v[142:143], v28 offset0:242 offset1:243
    v_mfma_f32_16x16x32_bf16 v[116:119], v[144:147], v[40:43], v[116:119]
    ds_read_b128 v[88:91], v30 offset:960
    v_mfma_f32_16x16x32_bf16 v[120:123], v[144:147], v[44:47], v[120:123]
    ds_read_b128 v[92:95], v30 offset:448
    v_mfma_f32_16x16x32_bf16 v[124:127], v[144:147], v[48:51], v[124:127]
    v_cndmask_b32 v204, 0, v6, vcc
    s_waitcnt lgkmcnt(10)
    v_mfma_f32_16x16x32_bf16 v[112:115], v[128:131], v[32:35], v[112:115]
    ds_read2_b32 v[144:145], v28 offset0:112 offset1:113
    v_mfma_f32_16x16x32_bf16 v[116:119], v[128:131], v[36:39], v[116:119]
    ds_read2_b32 v[146:147], v28 offset0:114 offset1:115
    v_mfma_f32_16x16x32_bf16 v[120:123], v[128:131], v[40:43], v[120:123]
    v_cndmask_b32 v182, v5, 0, vcc
    v_mfma_f32_16x16x32_bf16 v[124:127], v[128:131], v[44:47], v[124:127]
    v_cndmask_b32 v183, v6, 0, vcc
    s_waitcnt lgkmcnt(10)
    v_mfma_f32_16x16x32_bf16 v[124:127], v[132:135], v[64:67], v[124:127]
    ds_read2_b32 v[128:129], v27 offset0:240 offset1:241
    ds_read2_b32 v[130:131], v27 offset0:242 offset1:243
    s_waitcnt lgkmcnt(8)
    v_mfma_f32_16x16x32_bf16 v[120:123], v[136:139], v[64:67], v[120:123]
    ds_read2_b32 v[132:133], v27 offset0:112 offset1:113
    v_mfma_f32_16x16x32_bf16 v[124:127], v[136:139], v[68:71], v[124:127]
    ds_read2_b32 v[134:135], v27 offset0:114 offset1:115
    s_waitcnt lgkmcnt(8)
    v_mfma_f32_16x16x32_bf16 v[116:119], v[140:143], v[64:67], v[116:119]
    ds_read2_b32 v[136:137], v26 offset0:240 offset1:241
    v_mfma_f32_16x16x32_bf16 v[120:123], v[140:143], v[68:71], v[120:123]
    ds_read2_b32 v[138:139], v26 offset0:242 offset1:243
    v_mfma_f32_16x16x32_bf16 v[124:127], v[140:143], v[72:75], v[124:127]
    s_mov_b32 s74, 6554
    v_mul_u32_u24 v3, s74, v0
    s_waitcnt lgkmcnt(6)
    v_mfma_f32_16x16x32_bf16 v[112:115], v[144:147], v[64:67], v[112:115]
    ds_read2_b32 v[140:141], v26 offset0:112 offset1:113
    v_mfma_f32_16x16x32_bf16 v[116:119], v[144:147], v[68:71], v[116:119]
    ds_read2_b32 v[142:143], v26 offset0:114 offset1:115
    v_mfma_f32_16x16x32_bf16 v[120:123], v[144:147], v[72:75], v[120:123]
    v_lshrrev_b32 v3, 16, v3
    v_mfma_f32_16x16x32_bf16 v[124:127], v[144:147], v[76:79], v[124:127]
    v_mul_u32_u24 v3, 1120, v3
    s_waitcnt lgkmcnt(6)
    v_mfma_f32_16x16x32_bf16 v[108:111], v[128:131], v[64:67], v[108:111]
    v_lshl_add_u32 v208, v0, 4, v3
    v_mfma_f32_16x16x32_bf16 v[112:115], v[128:131], v[68:71], v[112:115]
    v_add_u32 v2, 512, v0
    v_mfma_f32_16x16x32_bf16 v[116:119], v[128:131], v[72:75], v[116:119]
    v_mul_u32_u24 v3, s74, v2
    v_mfma_f32_16x16x32_bf16 v[120:123], v[128:131], v[76:79], v[120:123]
    v_lshrrev_b32 v3, 16, v3
    v_mfma_f32_16x16x32_bf16 v[124:127], v[128:131], v[80:83], v[124:127]
    v_mul_u32_u24 v3, 1120, v3
    s_waitcnt lgkmcnt(4)
    v_mfma_f32_16x16x32_bf16 v[104:107], v[132:135], v[64:67], v[104:107]
    v_lshl_add_u32 v209, v2, 4, v3
    v_mfma_f32_16x16x32_bf16 v[108:111], v[132:135], v[68:71], v[108:111]
    v_add_u32 v2, 1024, v0
    v_mfma_f32_16x16x32_bf16 v[112:115], v[132:135], v[72:75], v[112:115]
    v_mul_u32_u24 v3, s74, v2
    v_mfma_f32_16x16x32_bf16 v[116:119], v[132:135], v[76:79], v[116:119]
    v_lshrrev_b32 v3, 16, v3
    v_mfma_f32_16x16x32_bf16 v[120:123], v[132:135], v[80:83], v[120:123]
    v_mul_u32_u24 v3, 1120, v3
    v_mfma_f32_16x16x32_bf16 v[124:127], v[132:135], v[84:87], v[124:127]
    v_lshl_add_u32 v210, v2, 4, v3
    s_waitcnt lgkmcnt(2)
    v_mfma_f32_16x16x32_bf16 v[100:103], v[136:139], v[64:67], v[100:103]
    v_add_u32 v2, 1536, v0
    v_mfma_f32_16x16x32_bf16 v[104:107], v[136:139], v[68:71], v[104:107]
    v_mul_u32_u24 v3, s74, v2
    v_mfma_f32_16x16x32_bf16 v[108:111], v[136:139], v[72:75], v[108:111]
    v_lshrrev_b32 v3, 16, v3
    v_mfma_f32_16x16x32_bf16 v[112:115], v[136:139], v[76:79], v[112:115]
    v_mul_u32_u24 v3, 1120, v3
    v_mfma_f32_16x16x32_bf16 v[116:119], v[136:139], v[80:83], v[116:119]
    v_lshl_add_u32 v211, v2, 4, v3
    v_mfma_f32_16x16x32_bf16 v[120:123], v[136:139], v[84:87], v[120:123]
    v_add_u32 v2, 2048, v0
    v_mfma_f32_16x16x32_bf16 v[124:127], v[136:139], v[88:91], v[124:127]
    v_mul_u32_u24 v3, s74, v2
    s_waitcnt lgkmcnt(0)
    v_mfma_f32_16x16x32_bf16 v[96:99], v[140:143], v[64:67], v[96:99]
    v_mfma_f32_16x16x32_bf16 v[100:103], v[140:143], v[68:71], v[100:103]
    v_mfma_f32_16x16x32_bf16 v[104:107], v[140:143], v[72:75], v[104:107]
    v_mfma_f32_16x16x32_bf16 v[108:111], v[140:143], v[76:79], v[108:111]
    s_nop 4
    v_cvt_pk_bf16_f32 v8, v96, v97
    v_cvt_pk_bf16_f32 v9, v98, v99
    ds_write_b64 v31, v[8:9] offset:0
    v_mfma_f32_16x16x32_bf16 v[112:115], v[140:143], v[80:83], v[112:115]
    v_cvt_pk_bf16_f32 v10, v100, v101
    v_cvt_pk_bf16_f32 v11, v102, v103
    ds_write_b64 v31, v[10:11] offset:512
    v_mfma_f32_16x16x32_bf16 v[116:119], v[140:143], v[84:87], v[116:119]
    v_cvt_pk_bf16_f32 v8, v104, v105
    v_cvt_pk_bf16_f32 v9, v106, v107
    ds_write_b64 v31, v[8:9] offset:1024
    v_mfma_f32_16x16x32_bf16 v[120:123], v[140:143], v[88:91], v[120:123]
    v_cvt_pk_bf16_f32 v10, v108, v109
    v_cvt_pk_bf16_f32 v11, v110, v111
    ds_write_b64 v31, v[10:11] offset:1536
    v_mfma_f32_16x16x32_bf16 v[124:127], v[140:143], v[92:95], v[124:127]
    v_cvt_pk_bf16_f32 v8, v112, v113
    v_cvt_pk_bf16_f32 v9, v114, v115
    ds_write_b64 v31, v[8:9] offset:2048
    v_lshrrev_b32 v3, 16, v3
    v_mul_u32_u24 v3, 1120, v3
    v_lshl_add_u32 v212, v2, 4, v3
    s_lshl_b32 s72, s56, 10
    s_add_u32 s24, s72, 87040
    s_add_u32 s25, s24, 73728
    s_sub_u32 s72, s72, 3072
    s_min_u32 s25, s25, s72
    s_add_u32 s26, s7, 327680
    v_cvt_pk_bf16_f32 v10, v116, v117
    v_cvt_pk_bf16_f32 v11, v118, v119
    ds_write_b64 v31, v[10:11] offset:2560
    v_cvt_pk_bf16_f32 v8, v120, v121
    v_cvt_pk_bf16_f32 v9, v122, v123
    ds_write_b64 v31, v[8:9] offset:3072
    v_cvt_pk_bf16_f32 v10, v124, v125
    v_cvt_pk_bf16_f32 v11, v126, v127
    ds_write_b64 v31, v[10:11] offset:3584
    ds_read_b128 v[32:35], v180 offset:0
    ds_read_b128 v[36:39], v180 offset:1024
    ds_read_b128 v[40:43], v180 offset:2048
    ds_read_b128 v[44:47], v180 offset:3072
    s_waitcnt lgkmcnt(3)
    buffer_store_dwordx4 v[32:35], v13, s[52:55], s82 offen offset:0 sc1
    s_waitcnt lgkmcnt(2)
    buffer_store_dwordx4 v[36:39], v13, s[52:55], s82 offen offset:1024 sc1
    s_waitcnt lgkmcnt(1)
    buffer_store_dwordx4 v[40:43], v13, s[52:55], s82 offen offset:2048 sc1
    s_waitcnt lgkmcnt(0)
    buffer_store_dwordx4 v[44:47], v13, s[52:55], s82 offen offset:3072 sc1
    s_branch L_join_a
L_C:
    s_mov_b32 s10, 2621440
    s_mov_b32 s11, 0x20000
    s_mov_b32 s14, 2457600
    s_mov_b32 s15, 0x20000
    s_mov_b32 s18, 819200
    s_mov_b32 s19, 0x20000
    s_mov_b32 s22, 2621440
    s_mov_b32 s23, 0x20000
    s_mov_b32 s38, 2621440
    s_mov_b32 s39, 0x20000
    s_mov_b32 s42, 1280
    s_mov_b32 s43, 0x20000
    s_mov_b32 s46, 5242880
    s_mov_b32 s47, 0x20000
    s_mov_b32 s50, 256
    s_mov_b32 s51, 0x20000
    s_mov_b32 s54, 25165824
    s_mov_b32 s55, 0x20000
    s_mov_b32 s67, 0
    s_mov_b32 s66, 0
    s_waitcnt lgkmcnt(0)
    s_or_b32 s70, s2, s56
    s_cmp_lg_u32 s70, 0
    s_cbranch_scc1 L_nonon
    s_memrealtime s[60:61]
    s_waitcnt lgkmcnt(0)
    s_or_b32 s60, s60, 1
    v_mov_b32 v6, s60
    v_mov_b32 v7, s61
    v_mov_b32 v5, 0
    s_mov_b64 exec, 1
    buffer_store_dwordx2 v[6:7], v5, s[48:51], 0 offen sc1
    s_mov_b64 exec, -1
L_nonon:
    s_cmp_ge_u32 s58, 30
    s_cbranch_scc1 L_c_idle
    s_and_b32 s70, s56, 1
    s_lshr_b32 s71, s56, 1
    v_and_b32 v2, 15, v1
    v_lshrrev_b32 v3, 4, v1
    v_lshrrev_b32 v4, 1, v2
    v_xor_b32 v4, v4, v3
    s_lshl_b32 s72, s71, 13
    v_lshlrev_b32 v5, 7, v2
    v_add_u32 v5, s72, v5
    v_xor_b32 v6, 0, v4
    v_lshl_add_u32 v48, v6, 4, v5
    v_add_u32 v50, 0x10000, v48
    v_xor_b32 v6, 4, v4
    v_lshl_add_u32 v49, v6, 4, v5
    v_add_u32 v51, 0x10000, v49
    v_bfe_u32 v4, v1, 2, 2
    v_lshl_add_u32 v5, v3, 3, v4
    v_lshlrev_b32 v5, 8, v5
    v_and_b32 v6, 3, v1
    v_lshl_add_u32 v5, v6, 3, v5
    v_and_b32 v6, 16, v1
    v_lshl_add_u32 v5, v6, 1, v5
    v_add_u32 v5, 16384, v5
    s_lshl_b32 s72, s70, 1
    s_add_u32 s73, s72, 0
    v_xor_b32 v6, s73, v4
    v_lshl_add_u32 v52, v6, 6, v5
    v_xor_b32 v53, 32, v52
    s_add_u32 s73, s72, 1
    v_xor_b32 v6, s73, v4
    v_lshl_add_u32 v54, v6, 6, v5
    v_xor_b32 v55, 32, v54
    v_add_u32 v56, 0x10000, v52
    v_add_u32 v57, 0x10000, v53
    v_add_u32 v58, 0x10000, v54
    v_add_u32 v59, 0x10000, v55
    v_and_b32 v2, 31, v1
    v_lshrrev_b32 v3, 5, v1
    v_lshlrev_b32 v3, 2, v3
    v_sub_u32 v2, v2, v3
    v_mov_b32 v3, 0xf149f2ca
    v_cmp_gt_i32 vcc, 0, v2
    v_cmp_gt_i32 s[80:81], 1, v2
    s_nop 0
    v_cndmask_b32 v224, 0, v3, vcc
    v_cndmask_b32 v225, 0, v3, s[80:81]
    v_cmp_gt_i32 vcc, 2, v2
    v_cmp_gt_i32 s[80:81], 3, v2
    v_xor_b32 v240, v3, v224
    v_xor_b32 v241, v3, v225
    v_cndmask_b32 v226, 0, v3, vcc
    v_cndmask_b32 v227, 0, v3, s[80:81]
    v_cmp_gt_i32 vcc, 8, v2
    v_cmp_gt_i32 s[80:81], 9, v2
    v_xor_b32 v242, v3, v226
    v_xor_b32 v243, v3, v227
    v_cndmask_b32 v228, 0, v3, vcc
    v_cndmask_b32 v229, 0, v3, s[80:81]
    v_cmp_gt_i32 vcc, 10, v2
    v_cmp_gt_i32 s[80:81], 11, v2
    v_xor_b32 v244, v3, v228
    v_xor_b32 v245, v3, v229
    v_cndmask_b32 v230, 0, v3, vcc
    v_cndmask_b32 v231, 0, v3, s[80:81]
    v_cmp_gt_i32 vcc, 16, v2
    v_cmp_gt_i32 s[80:81], 17, v2
    v_xor_b32 v246, v3, v230
    v_xor_b32 v247, v3, v231
    v_cndmask_b32 v232, 0, v3, vcc
    v_cndmask_b32 v233, 0, v3, s[80:81]
    v_cmp_gt_i32 vcc, 18, v2
    v_cmp_gt_i32 s[80:81], 19, v2
    v_xor_b32 v248, v3, v232
    v_xor_b32 v249, v3, v233
    v_cndmask_b32 v234, 0, v3, vcc
    v_cndmask_b32 v235, 0, v3, s[80:81]
    v_cmp_gt_i32 vcc, 24, v2
    v_cmp_gt_i32 s[80:81], 25, v2
    v_xor_b32 v250, v3, v234
    v_xor_b32 v251, v3, v235
    v_cndmask_b32 v236, 0, v3, vcc
    v_cndmask_b32 v237, 0, v3, s[80:81]
    v_cmp_gt_i32 vcc, 26, v2
    v_cmp_gt_i32 s[80:81], 27, v2
    v_xor_b32 v252, v3, v236
    v_xor_b32 v253, v3, v237
    v_cndmask_b32 v238, 0, v3, vcc
    v_cndmask_b32 v239, 0, v3, s[80:81]
    v_xor_b32 v254, v3, v238
    v_xor_b32 v255, v3, v239
    s_lshl_b32 s70, s56, 9
    v_and_b32 v2, 31, v1
    v_lshrrev_b32 v3, 5, v1
    v_lshlrev_b32 v206, 3, v2
    v_lshlrev_b32 v4, 4, v2
    v_lshl_add_u32 v205, v3, 15, v4
    v_add_u32 v4, s70, v4
    v_lshl_add_u32 v5, v3, 12, v4
    v_add_u32 v201, 83712, v5
    v_add_u32 v202, 91904, v4
    v_lshl_add_u32 v197, v3, 13, v4
    v_add_u32 v197, 59136, v197
    v_lshlrev_b32 v5, 9, v3
    v_sub_u32 v5, v4, v5
    v_add_u32 v198, 75520, v5
    v_bfe_u32 v4, v1, 2, 2
    v_lshl_add_u32 v4, v3, 2, v4
    v_lshlrev_b32 v4, 4, v4
    v_bfe_u32 v5, v1, 1, 1
    v_mul_u32_u24 v5, 8256, v5
    v_and_b32 v6, 1, v1
    v_lshl_add_u32 v5, v6, 3, v5
    s_and_b32 s71, s68, 1
    s_lshl_b32 s72, s71, 3
    s_add_u32 s72, s72, 16512
    v_mov_b32 v6, s72
    v_and_b32 v7, 16, v1
    v_cmp_ne_u32 vcc, 0, v7
    s_nop 1
    v_cndmask_b32 v5, v5, v6, vcc
    s_add_u32 s70, s70, 36352
    v_add3_u32 v5, v5, v4, s70
    v_and_b32 v7, 2, v1
    v_sub_u32 v7, 2, v7
    v_lshl_add_u32 v4, v7, 2, v4
    v_and_b32 v7, 19, v1
    v_cmp_lt_u32 vcc, 16, v7
    s_add_u32 s70, s56, 1
    s_cmp_eq_u32 s69, 0
    s_cselect_b32 s77, s70, 99
    s_cmp_gt_u32 s77, 0
    s_cselect_b32 s70, 24576, 0
    s_add_u32 s70, s70, 32960
    s_cmp_gt_u32 s77, 1
    s_cselect_b32 s70, 58048, s70
    v_add_u32 v6, s70, v4
    v_cndmask_b32 v190, v5, v6, vcc
    v_subrev_u32 v5, 1024, v5
    s_cmp_gt_u32 s77, 2
    s_cselect_b32 s70, 24576, 0
    s_add_u32 s70, s70, 32960
    s_cmp_gt_u32 s77, 3
    s_cselect_b32 s70, 58048, s70
    v_add_u32 v6, s70, v4
    v_cndmask_b32 v191, v5, v6, vcc
    v_subrev_u32 v5, 1024, v5
    s_cmp_gt_u32 s77, 4
    s_cselect_b32 s70, 24576, 0
    s_add_u32 s70, s70, 32960
    s_cmp_gt_u32 s77, 5
    s_cselect_b32 s70, 58048, s70
    v_add_u32 v6, s70, v4
    v_cndmask_b32 v192, v5, v6, vcc
    v_subrev_u32 v5, 1024, v5
    s_cmp_gt_u32 s77, 6
    s_cselect_b32 s70, 24576, 0
    s_add_u32 s70, s70, 32960
    s_cmp_gt_u32 s77, 7
    s_cselect_b32 s70, 58048, s70
    v_add_u32 v6, s70, v4
    v_cndmask_b32 v193, v5, v6, vcc
    v_subrev_u32 v5, 1024, v5
    s_cmp_gt_u32 s77, 8
    s_cselect_b32 s70, 24576, 0
    s_add_u32 s70, s70, 32960
    s_cmp_gt_u32 s77, 9
    s_cselect_b32 s70, 58048, s70
    v_add_u32 v6, s70, v4
    v_cndmask_b32 v194, v5, v6, vcc
    v_subrev_u32 v5, 1024, v5
    s_mov_b32 s78, 0
    s_cmp_eq_u32 s71, 0
    s_cselect_b32 s72, -1, 0
    s_cselect_b32 s73, 0, -1
    v_cmp_eq_u32 vcc, 0, v3
    v_mov_b32 v5, s72
    v_mov_b32 v6, s73
    v_cndmask_b32 v203, 0, v5, vcc
    v_cndmask_b32 v204, 0, v6, vcc
    v_cndmask_b32 v182, v5, 0, vcc
    v_cndmask_b32 v183, v6, 0, vcc
    s_mov_b32 s74, 6554
    v_mul_u32_u24 v3, s74, v0
    v_lshrrev_b32 v3, 16, v3
    v_mul_u32_u24 v3, 1120, v3
    v_lshl_add_u32 v208, v0, 4, v3
    v_add_u32 v2, 512, v0
    v_mul_u32_u24 v3, s74, v2
    v_lshrrev_b32 v3, 16, v3
    v_mul_u32_u24 v3, 1120, v3
    v_lshl_add_u32 v209, v2, 4, v3
    v_add_u32 v2, 1024, v0
    v_mul_u32_u24 v3, s74, v2
    v_lshrrev_b32 v3, 16, v3
    v_mul_u32_u24 v3, 1120, v3
    v_lshl_add_u32 v210, v2, 4, v3
    v_add_u32 v2, 1536, v0
    v_mul_u32_u24 v3, s74, v2
    v_lshrrev_b32 v3, 16, v3
    v_mul_u32_u24 v3, 1120, v3
    v_lshl_add_u32 v211, v2, 4, v3
    v_add_u32 v2, 2048, v0
    v_mul_u32_u24 v3, s74, v2
    v_lshrrev_b32 v3, 16, v3
    v_mul_u32_u24 v3, 1120, v3
    v_lshl_add_u32 v212, v2, 4, v3
    s_lshr_b32 s70, s68, 1
    s_mul_i32 s70, s70, 5
    s_and_b32 s71, s68, 1
    s_lshl_b32 s72, s71, 1
    s_add_u32 s72, s72, s70
    s_add_u32 s73, s72, 2
    s_lshr_b32 s72, s72, 3
    s_lshr_b32 s73, s73, 3
    s_lshr_b32 s74, s68, 2
    s_mul_i32 s0, s74, 10
    s_lshr_b32 s0, s0, 3
    s_sub_u32 s72, s72, s0
    s_sub_u32 s73, s73, s0
    s_cmp_eq_u32 s69, 0
    s_cselect_b32 s0, 2, 4
    v_lshrrev_b32 v2, 1, v1
    v_min_u32 v2, s0, v2
    v_and_b32 v4, 1, v1
    v_cmp_eq_u32 vcc, 1, v4
    v_mov_b32 v4, s72
    v_mov_b32 v5, s73
    v_cndmask_b32 v4, v4, v5, vcc
    v_lshl_add_u32 v2, v2, 1, v4
    s_lshl_b32 s0, s74, 5
    s_lshl_b32 s74, s69, 2
    s_add_u32 s74, s74, s56
    s_add_u32 s0, s0, s74
    s_lshl_b32 s0, s0, 8
    s_add_u32 s0, s0, 17825792
    v_lshl_add_u32 v207, v2, 4, s0
    s_lshl_b32 s1, s62, 2
    s_add_u32 s1, s1, s56
    s_lshl_b32 s1, s1, 9
    s_add_u32 s1, s1, 18612224
    v_and_b32 v2, 15, v1
    v_lshl_add_u32 v199, v2, 5, s1
    s_mul_i32 s71, s71, 3
    s_add_u32 s0, s70, s71
    s_add_u32 s1, s70, 2
    s_lshl_b32 s0, s0, 15
    s_lshl_b32 s1, s1, 15
    s_lshl_b32 s74, s74, 10
    s_add_u32 s0, s0, s74
    s_add_u32 s1, s1, s74
    v_lshlrev_b32 v14, 4, v1
    v_bfrev_b32 v15, 1
    s_cmp_eq_u32 s69, 0
    s_cselect_b64 vcc, -1, 0
    v_cndmask_b32 v15, v14, v15, vcc
    s_lshl_b32 s75, s56, 10
    s_and_b32 s70, s56, 1
    s_lshl_b32 s72, s65, 1
    s_add_u32 s72, s72, s70
    s_mul_i32 s70, s72, 26
    s_lshr_b32 s70, s70, 8
    s_mul_i32 s71, s70, 10
    s_sub_u32 s72, s72, s71
    s_cmp_ge_u32 s72, 5
    s_cselect_b32 s71, 5, 0
    s_cselect_b32 s74, 4, 0
    s_sub_u32 s72, s72, s71
    s_lshr_b32 s71, s56, 1
    s_lshl_b32 s73, s64, 1
    s_add_u32 s73, s73, s71
    v_and_b32 v2, 1, v1
    v_lshrrev_b32 v3, 1, v1
    v_sub_u32 v4, s72, v2
    v_cmp_gt_u32 vcc, 4, v4
    v_add_u32 v4, s74, v4
    v_lshl_add_u32 v5, v3, 2, s73
    v_cmp_gt_u32 s[80:81], 32, v5
    s_nop 0
    s_and_b64 vcc, vcc, s[80:81]
    s_cmp_eq_u32 s70, 0
    s_cselect_b32 s71, 3, 15
    s_and_b32 vcc_lo, vcc_lo, s71
    s_mov_b32 vcc_hi, 0
    v_lshl_add_u32 v4, v4, 5, v5
    v_lshlrev_b32 v4, 7, v4
    v_lshl_add_u32 v5, v3, 1, s70
    v_lshl_add_u32 v5, v5, 1, v2
    v_lshl_add_u32 v4, v5, 3, v4
    v_lshlrev_b32 v4, 1, v4
    v_add_u32 v4, 17825792, v4
    v_bfrev_b32 v5, 1
    v_cndmask_b32 v200, v5, v4, vcc
    s_lshl_b32 s72, s56, 10
    s_add_u32 s24, s72, 87040
    s_add_u32 s25, s24, 73728
    s_sub_u32 s72, s72, 3072
    s_min_u32 s25, s25, s72
    s_add_u32 s26, s7, 327680
    v_mov_b32 v2, 119728
    v_mov_b32 v3, 1
    s_mov_b32 s76, 0
    s_waitcnt vmcnt(0)
    s_mov_b64 exec, 1
    ds_add_u32 v2, v3
    s_mov_b64 exec, -1
    v_mov_b32 v62, 0
    buffer_load_dwordx2 v[60:61], v62, s[48:51], 0 offen sc1
    buffer_load_dword v63, v207, s[52:55], 0 offen sc1
    buffer_load_dword v63, v199, s[52:55], 0 offen sc1
L_b1s:
    ds_read_b32 v3, v2
    s_add_u32 s76, s76, 1
    s_waitcnt lgkmcnt(0)
    v_cmp_ne_u32 vcc, 8, v3
    s_cmp_gt_u32 s76, 0x100000
    s_cbranch_scc1 L_b1t
    s_cbranch_vccnz L_b1s
L_b1t:
    v_and_b32 v2, 7, v0
    v_lshrrev_b32 v3, 3, v0
    v_mul_u32_u24 v4, 1296, v2
    v_lshl_add_u32 v4, v3, 2, v4
    v_add_u32 v4, 98304, v4
    ds_read_b32 v128, v4 offset:160
    ds_read_b32 v129, v4 offset:320
    ds_read_b32 v130, v4 offset:480
    ds_read_b32 v131, v4 offset:656
    ds_read_b32 v132, v4 offset:816
    ds_read_b32 v133, v4 offset:976
    ds_read_b32 v134, v4 offset:1136
    ds_read_b32 v135, v4 offset:1296
    ds_read_b32 v136, v4 offset:1456
    ds_read_b32 v137, v4 offset:1616
    ds_read_b32 v138, v4 offset:1776
    ds_read_b32 v144, v4 offset:11024
    ds_read_b32 v145, v4 offset:11184
    ds_read_b32 v146, v4 offset:11344
    ds_read_b32 v147, v4 offset:11504
    ds_read_b32 v148, v4 offset:11664
    ds_read_b32 v149, v4 offset:11824
    ds_read_b32 v150, v4 offset:11984
    ds_read_b32 v151, v4 offset:12144
    v_lshlrev_b32 v3, 13, v3
    v_sub_u32 v2, 7, v2
    v_lshl_add_u32 v3, v2, 4, v3
    v_and_b32 v2, 31, v0
    v_lshrrev_b32 v4, 5, v0
    v_mul_u32_u24 v5, 320, v2
    v_lshl_add_u32 v5, v4, 2, v5
    v_add_u32 v5, 98432, v5
    v_add_u32 v6, 3, v2
    v_lshrrev_b32 v6, 2, v6
    v_lshl_add_u32 v6, v6, 4, v5
    v_add_u32 v7, 2, v2
    v_lshrrev_b32 v7, 2, v7
    v_lshl_add_u32 v7, v7, 4, v5
    v_lshrrev_b32 v188, 2, v2
    v_lshl_add_u32 v5, v188, 4, v5
    ds_read_b32 v7, v7 offset:160
    ds_read_b32 v188, v6 offset:320
    ds_read_b32 v6, v6 offset:480
    ds_read_b32 v189, v5 offset:656
    ds_read_b32 v195, v5 offset:816
    ds_read_b32 v196, v5 offset:11024
    ds_read_b32 v5, v5 offset:11184
    v_lshlrev_b32 v2, 2, v2
    v_sub_u32 v2, 262268, v2
    v_lshl_add_u32 v2, v4, 13, v2
    v_lshlrev_b32 v174, 16, v8
    v_lshlrev_b32 v175, 16, v10
    v_and_b32 v176, 0xffff0000, v8
    v_and_b32 v177, 0xffff0000, v10
    v_lshlrev_b32 v178, 16, v9
    v_lshlrev_b32 v179, 16, v11
    v_and_b32 v180, 0xffff0000, v9
    v_and_b32 v181, 0xffff0000, v11
    s_mul_i32 s70, s63, 327680
    s_lshl_b32 s71, s62, 7
    s_sub_u32 s70, s70, s71
    s_add_u32 s70, s70, 8392576
    s_waitcnt lgkmcnt(15)
    v_lshlrev_b32 v152, 16, v128
    v_and_b32 v153, 0xffff0000, v128
    v_lshlrev_b32 v154, 16, v129
    v_and_b32 v155, 0xffff0000, v129
    v_lshlrev_b32 v156, 16, v130
    v_and_b32 v157, 0xffff0000, v130
    v_lshlrev_b32 v158, 16, v131
    v_and_b32 v159, 0xffff0000, v131
    v_lshlrev_b32 v160, 16, v132
    v_and_b32 v161, 0xffff0000, v132
    v_lshlrev_b32 v162, 16, v133
    v_and_b32 v163, 0xffff0000, v133
    v_lshlrev_b32 v164, 16, v134
    v_and_b32 v165, 0xffff0000, v134
    v_lshlrev_b32 v166, 16, v135
    v_and_b32 v167, 0xffff0000, v135
    v_lshlrev_b32 v168, 16, v136
    v_and_b32 v169, 0xffff0000, v136
    v_lshlrev_b32 v170, 16, v137
    v_and_b32 v171, 0xffff0000, v137
    v_lshlrev_b32 v172, 16, v138
    v_and_b32 v173, 0xffff0000, v138
    v_pk_mul_f32 v[128:129], v[158:159], v[174:175]
    v_pk_mul_f32 v[130:131], v[160:161], v[174:175]
    v_pk_mul_f32 v[132:133], v[162:163], v[174:175]
    v_pk_mul_f32 v[134:135], v[164:165], v[174:175]
    v_pk_mul_f32 v[136:137], v[166:167], v[174:175]
    v_pk_mul_f32 v[138:139], v[168:169], v[174:175]
    v_pk_mul_f32 v[140:141], v[170:171], v[174:175]
    v_pk_mul_f32 v[142:143], v[172:173], v[174:175]
    v_pk_fma_f32 v[128:129], v[156:157], v[176:177], v[128:129]
    v_pk_fma_f32 v[130:131], v[158:159], v[176:177], v[130:131]
    v_pk_fma_f32 v[132:133], v[160:161], v[176:177], v[132:133]
    v_pk_fma_f32 v[134:135], v[162:163], v[176:177], v[134:135]
    v_pk_fma_f32 v[136:137], v[164:165], v[176:177], v[136:137]
    v_pk_fma_f32 v[138:139], v[166:167], v[176:177], v[138:139]
    v_pk_fma_f32 v[140:141], v[168:169], v[176:177], v[140:141]
    v_pk_fma_f32 v[142:143], v[170:171], v[176:177], v[142:143]
    v_pk_fma_f32 v[128:129], v[154:155], v[178:179], v[128:129]
    v_pk_fma_f32 v[130:131], v[156:157], v[178:179], v[130:131]
    v_pk_fma_f32 v[132:133], v[158:159], v[178:179], v[132:133]
    v_pk_fma_f32 v[134:135], v[160:161], v[178:179], v[134:135]
    v_pk_fma_f32 v[136:137], v[162:163], v[178:179], v[136:137]
    v_pk_fma_f32 v[138:139], v[164:165], v[178:179], v[138:139]
    v_pk_fma_f32 v[140:141], v[166:167], v[178:179], v[140:141]
    v_pk_fma_f32 v[142:143], v[168:169], v[178:179], v[142:143]
    v_pk_fma_f32 v[128:129], v[152:153], v[180:181], v[128:129]
    v_pk_fma_f32 v[130:131], v[154:155], v[180:181], v[130:131]
    v_pk_fma_f32 v[132:133], v[156:157], v[180:181], v[132:133]
    v_pk_fma_f32 v[134:135], v[158:159], v[180:181], v[134:135]
    v_pk_fma_f32 v[136:137], v[160:161], v[180:181], v[136:137]
    v_pk_fma_f32 v[138:139], v[162:163], v[180:181], v[138:139]
    v_pk_fma_f32 v[140:141], v[164:165], v[180:181], v[140:141]
    v_pk_fma_f32 v[142:143], v[166:167], v[180:181], v[142:143]
    s_waitcnt lgkmcnt(7)
    v_lshlrev_b32 v152, 16, v144
    v_and_b32 v153, 0xffff0000, v144
    v_lshlrev_b32 v154, 16, v145
    v_and_b32 v155, 0xffff0000, v145
    v_lshlrev_b32 v156, 16, v146
    v_and_b32 v157, 0xffff0000, v146
    v_lshlrev_b32 v158, 16, v147
    v_and_b32 v159, 0xffff0000, v147
    v_lshlrev_b32 v160, 16, v148
    v_and_b32 v161, 0xffff0000, v148
    v_lshlrev_b32 v162, 16, v149
    v_and_b32 v163, 0xffff0000, v149
    v_lshlrev_b32 v164, 16, v150
    v_and_b32 v165, 0xffff0000, v150
    v_lshlrev_b32 v166, 16, v151
    v_and_b32 v167, 0xffff0000, v151
    v_pk_mul_f32 v[128:129], v[128:129], v[152:153]
    v_pk_mul_f32 v[130:131], v[130:131], v[154:155]
    v_pk_mul_f32 v[132:133], v[132:133], v[156:157]
    v_pk_mul_f32 v[134:135], v[134:135], v[158:159]
    v_pk_mul_f32 v[136:137], v[136:137], v[160:161]
    v_pk_mul_f32 v[138:139], v[138:139], v[162:163]
    v_pk_mul_f32 v[140:141], v[140:141], v[164:165]
    v_pk_mul_f32 v[142:143], v[142:143], v[166:167]
    v_cvt_pk_bf16_f32 v168, v142, v140
    v_cvt_pk_bf16_f32 v169, v138, v136
    v_cvt_pk_bf16_f32 v170, v134, v132
    v_cvt_pk_bf16_f32 v171, v130, v128
    v_cvt_pk_bf16_f32 v172, v143, v141
    v_cvt_pk_bf16_f32 v173, v139, v137
    v_cvt_pk_bf16_f32 v174, v135, v133
    v_cvt_pk_bf16_f32 v175, v131, v129
    v_lshlrev_b32 v146, 16, v184
    v_lshlrev_b32 v147, 16, v186
    v_and_b32 v148, 0xffff0000, v184
    v_and_b32 v149, 0xffff0000, v186
    v_lshlrev_b32 v150, 16, v185
    v_lshlrev_b32 v151, 16, v187
    v_and_b32 v152, 0xffff0000, v185
    v_and_b32 v153, 0xffff0000, v187
    s_waitcnt lgkmcnt(0)
    v_lshlrev_b32 v132, 16, v7
    v_and_b32 v133, 0xffff0000, v7
    v_lshlrev_b32 v134, 16, v188
    v_and_b32 v135, 0xffff0000, v188
    v_lshlrev_b32 v136, 16, v6
    v_and_b32 v137, 0xffff0000, v6
    v_lshlrev_b32 v138, 16, v189
    v_and_b32 v139, 0xffff0000, v189
    v_lshlrev_b32 v140, 16, v195
    v_and_b32 v141, 0xffff0000, v195
    v_lshlrev_b32 v142, 16, v196
    v_and_b32 v143, 0xffff0000, v196
    v_lshlrev_b32 v144, 16, v5
    v_and_b32 v145, 0xffff0000, v5
    v_pk_mul_f32 v[128:129], v[138:139], v[146:147]
    v_pk_mul_f32 v[130:131], v[140:141], v[146:147]
    v_pk_fma_f32 v[128:129], v[136:137], v[148:149], v[128:129]
    v_pk_fma_f32 v[130:131], v[138:139], v[148:149], v[130:131]
    v_pk_fma_f32 v[128:129], v[134:135], v[150:151], v[128:129]
    v_pk_fma_f32 v[130:131], v[136:137], v[150:151], v[130:131]
    v_pk_fma_f32 v[128:129], v[132:133], v[152:153], v[128:129]
    v_pk_fma_f32 v[130:131], v[134:135], v[152:153], v[130:131]
    v_pk_mul_f32 v[128:129], v[128:129], v[142:143]
    v_pk_mul_f32 v[130:131], v[130:131], v[144:145]
    v_cvt_pk_bf16_f32 v176, v130, v128
    v_cvt_pk_bf16_f32 v177, v131, v129
    v_add_u32 v178, s70, v3
    v_add_u32 v179, s70, v2
    s_movk_i32 s71, 0x1000
    buffer_store_dwordx4 v[168:171], v178, s[52:55], 0 offen sc1
    buffer_store_dwordx4 v[172:175], v178, s[52:55], s71 offen sc1
    buffer_store_dword v176, v179, s[52:55], 0 offen sc1
    buffer_store_dword v177, v179, s[52:55], s71 offen sc1
    s_waitcnt lgkmcnt(0)
    s_barrier
    ds_read_b128 v[144:147], v48 offset:32768
    ds_read_b128 v[148:151], v48 offset:34816
    ds_read_b128 v[152:155], v48 offset:36864
    ds_read_b128 v[156:159], v48 offset:38912
    ds_read_b64_tr_b16 v[128:129], v52 offset:32768
    ds_read_b64_tr_b16 v[130:131], v52 offset:33792
    ds_read_b64_tr_b16 v[132:133], v53 offset:32768
    ds_read_b64_tr_b16 v[134:135], v53 offset:33792
    ds_read_b64_tr_b16 v[136:137], v54 offset:32768
    ds_read_b64_tr_b16 v[138:139], v54 offset:33792
    ds_read_b64_tr_b16 v[140:141], v55 offset:32768
    ds_read_b64_tr_b16 v[142:143], v55 offset:33792
    s_waitcnt lgkmcnt(6)
    v_mfma_f32_16x16x32_bf16 v[64:67], v[128:131], v[144:147], 0
    ds_read_b128 v[32:35], v49 offset:32768
    v_mfma_f32_16x16x32_bf16 v[68:71], v[128:131], v[148:151], 0
    ds_read_b128 v[36:39], v49 offset:34816
    v_mfma_f32_16x16x32_bf16 v[72:75], v[128:131], v[152:155], 0
    ds_read_b128 v[40:43], v49 offset:36864
    v_mfma_f32_16x16x32_bf16 v[76:79], v[128:131], v[156:159], 0
    ds_read_b128 v[44:47], v49 offset:38912
    s_waitcnt lgkmcnt(8)
    v_mfma_f32_16x16x32_bf16 v[92:95], v[132:135], v[156:159], 0
    ds_read_b64_tr_b16 v[16:17], v52 offset:40960
    v_mfma_f32_16x16x32_bf16 v[88:91], v[132:135], v[152:155], 0
    ds_read_b64_tr_b16 v[18:19], v52 offset:41984
    v_mfma_f32_16x16x32_bf16 v[84:87], v[132:135], v[148:151], 0
    ds_read_b64_tr_b16 v[20:21], v53 offset:40960
    v_mfma_f32_16x16x32_bf16 v[80:83], v[132:135], v[144:147], 0
    ds_read_b64_tr_b16 v[22:23], v53 offset:41984
    s_waitcnt lgkmcnt(10)
    v_mfma_f32_16x16x32_bf16 v[96:99], v[136:139], v[144:147], 0
    ds_read_b64_tr_b16 v[24:25], v54 offset:40960
    v_mfma_f32_16x16x32_bf16 v[100:103], v[136:139], v[148:151], 0
    ds_read_b64_tr_b16 v[26:27], v54 offset:41984
    v_mfma_f32_16x16x32_bf16 v[104:107], v[136:139], v[152:155], 0
    ds_read_b64_tr_b16 v[28:29], v55 offset:40960
    v_mfma_f32_16x16x32_bf16 v[108:111], v[136:139], v[156:159], 0
    ds_read_b64_tr_b16 v[30:31], v55 offset:41984
    s_waitcnt lgkmcnt(12)
    v_mfma_f32_16x16x32_bf16 v[124:127], v[140:143], v[156:159], 0
    v_mfma_f32_16x16x32_bf16 v[120:123], v[140:143], v[152:155], 0
    v_mfma_f32_16x16x32_bf16 v[116:119], v[140:143], v[148:151], 0
    v_mfma_f32_16x16x32_bf16 v[112:115], v[140:143], v[144:147], 0
    s_waitcnt lgkmcnt(6)
    v_mfma_f32_16x16x32_bf16 v[64:67], v[16:19], v[32:35], v[64:67]
    v_mfma_f32_16x16x32_bf16 v[68:71], v[16:19], v[36:39], v[68:71]
    v_mfma_f32_16x16x32_bf16 v[72:75], v[16:19], v[40:43], v[72:75]
    v_mfma_f32_16x16x32_bf16 v[76:79], v[16:19], v[44:47], v[76:79]
    s_waitcnt lgkmcnt(0)
    s_barrier
    ds_read_b128 v[144:147], v50 offset:0
    ds_read_b128 v[148:151], v50 offset:2048
    v_mfma_f32_16x16x32_bf16 v[92:95], v[20:23], v[44:47], v[92:95]
    ds_read_b128 v[152:155], v50 offset:4096
    v_mfma_f32_16x16x32_bf16 v[88:91], v[20:23], v[40:43], v[88:91]
    ds_read_b128 v[156:159], v50 offset:6144
    v_mfma_f32_16x16x32_bf16 v[84:87], v[20:23], v[36:39], v[84:87]
    ds_read_b64_tr_b16 v[128:129], v56 offset:0
    v_mfma_f32_16x16x32_bf16 v[80:83], v[20:23], v[32:35], v[80:83]
    ds_read_b64_tr_b16 v[130:131], v56 offset:1024
    v_mfma_f32_16x16x32_bf16 v[96:99], v[24:27], v[32:35], v[96:99]
    ds_read_b64_tr_b16 v[132:133], v57 offset:0
    v_mfma_f32_16x16x32_bf16 v[100:103], v[24:27], v[36:39], v[100:103]
    ds_read_b64_tr_b16 v[134:135], v57 offset:1024
    v_mfma_f32_16x16x32_bf16 v[104:107], v[24:27], v[40:43], v[104:107]
    ds_read_b64_tr_b16 v[136:137], v58 offset:0
    v_mfma_f32_16x16x32_bf16 v[108:111], v[24:27], v[44:47], v[108:111]
    ds_read_b64_tr_b16 v[138:139], v58 offset:1024
    v_mfma_f32_16x16x32_bf16 v[124:127], v[28:31], v[44:47], v[124:127]
    ds_read_b64_tr_b16 v[140:141], v59 offset:0
    v_mfma_f32_16x16x32_bf16 v[120:123], v[28:31], v[40:43], v[120:123]
    ds_read_b64_tr_b16 v[142:143], v59 offset:1024
    v_mfma_f32_16x16x32_bf16 v[116:119], v[28:31], v[36:39], v[116:119]
    v_mfma_f32_16x16x32_bf16 v[112:115], v[28:31], v[32:35], v[112:115]
    s_waitcnt lgkmcnt(6)
    v_mfma_f32_16x16x32_bf16 v[64:67], v[128:131], v[144:147], v[64:67]
    ds_read_b128 v[32:35], v51 offset:0
    v_mfma_f32_16x16x32_bf16 v[68:71], v[128:131], v[148:151], v[68:71]
    ds_read_b128 v[36:39], v51 offset:2048
    v_mfma_f32_16x16x32_bf16 v[72:75], v[128:131], v[152:155], v[72:75]
    ds_read_b128 v[40:43], v51 offset:4096
    v_mfma_f32_16x16x32_bf16 v[76:79], v[128:131], v[156:159], v[76:79]
    ds_read_b128 v[44:47], v51 offset:6144
    s_waitcnt lgkmcnt(8)
    v_mfma_f32_16x16x32_bf16 v[92:95], v[132:135], v[156:159], v[92:95]
    ds_read_b64_tr_b16 v[16:17], v56 offset:8192
    v_mfma_f32_16x16x32_bf16 v[88:91], v[132:135], v[152:155], v[88:91]
    ds_read_b64_tr_b16 v[18:19], v56 offset:9216
    v_mfma_f32_16x16x32_bf16 v[84:87], v[132:135], v[148:151], v[84:87]
    ds_read_b64_tr_b16 v[20:21], v57 offset:8192
    v_mfma_f32_16x16x32_bf16 v[80:83], v[132:135], v[144:147], v[80:83]
    ds_read_b64_tr_b16 v[22:23], v57 offset:9216
    s_waitcnt lgkmcnt(10)
    v_mfma_f32_16x16x32_bf16 v[96:99], v[136:139], v[144:147], v[96:99]
    ds_read_b64_tr_b16 v[24:25], v58 offset:8192
    v_mfma_f32_16x16x32_bf16 v[100:103], v[136:139], v[148:151], v[100:103]
    ds_read_b64_tr_b16 v[26:27], v58 offset:9216
    v_mfma_f32_16x16x32_bf16 v[104:107], v[136:139], v[152:155], v[104:107]
    ds_read_b64_tr_b16 v[28:29], v59 offset:8192
    v_mfma_f32_16x16x32_bf16 v[108:111], v[136:139], v[156:159], v[108:111]
    ds_read_b64_tr_b16 v[30:31], v59 offset:9216
    s_waitcnt lgkmcnt(12)
    v_mfma_f32_16x16x32_bf16 v[124:127], v[140:143], v[156:159], v[124:127]
    v_mfma_f32_16x16x32_bf16 v[120:123], v[140:143], v[152:155], v[120:123]
    v_mfma_f32_16x16x32_bf16 v[116:119], v[140:143], v[148:151], v[116:119]
    v_mfma_f32_16x16x32_bf16 v[112:115], v[140:143], v[144:147], v[112:115]
    s_waitcnt lgkmcnt(6)
    v_mfma_f32_16x16x32_bf16 v[64:67], v[16:19], v[32:35], v[64:67]
    v_mfma_f32_16x16x32_bf16 v[68:71], v[16:19], v[36:39], v[68:71]
    v_mfma_f32_16x16x32_bf16 v[72:75], v[16:19], v[40:43], v[72:75]
    v_mfma_f32_16x16x32_bf16 v[76:79], v[16:19], v[44:47], v[76:79]
    s_waitcnt lgkmcnt(0)
    v_lshlrev_b32 v2, 4, v1
    v_add_u32 v2, 110592, v2
    s_cmp_lg_u32 s56, 0
    s_cbranch_scc1 L_mw_6
    ds_write_b128 v2, v[224:227] offset:0
    ds_write_b128 v2, v[228:231] offset:1024
L_mw_6:
    s_cmp_lg_u32 s56, 1
    s_cbranch_scc1 L_mw_7
    ds_write_b128 v2, v[232:235] offset:2048
    ds_write_b128 v2, v[236:239] offset:3072
L_mw_7:
    s_cmp_lg_u32 s56, 2
    s_cbranch_scc1 L_mw_8
    ds_write_b128 v2, v[240:243] offset:4096
    ds_write_b128 v2, v[244:247] offset:5120
L_mw_8:
    s_cmp_lg_u32 s56, 3
    s_cbranch_scc1 L_mw_9
    ds_write_b128 v2, v[248:251] offset:6144
    ds_write_b128 v2, v[252:255] offset:7168
L_mw_9:
    s_waitcnt lgkmcnt(0)
    s_barrier
    ds_read_b128 v[144:147], v48 offset:0
    ds_read_b128 v[148:151], v48 offset:2048
    v_mfma_f32_16x16x32_bf16 v[92:95], v[20:23], v[44:47], v[92:95]
    ds_read_b128 v[152:155], v48 offset:4096
    v_mfma_f32_16x16x32_bf16 v[88:91], v[20:23], v[40:43], v[88:91]
    ds_read_b128 v[156:159], v48 offset:6144
    v_mfma_f32_16x16x32_bf16 v[84:87], v[20:23], v[36:39], v[84:87]
    ds_read_b64_tr_b16 v[128:129], v52 offset:0
    v_mfma_f32_16x16x32_bf16 v[80:83], v[20:23], v[32:35], v[80:83]
    ds_read_b64_tr_b16 v[130:131], v52 offset:1024
    v_mfma_f32_16x16x32_bf16 v[96:99], v[24:27], v[32:35], v[96:99]
    ds_read_b64_tr_b16 v[132:133], v53 offset:0
    v_mfma_f32_16x16x32_bf16 v[100:103], v[24:27], v[36:39], v[100:103]
    ds_read_b64_tr_b16 v[134:135], v53 offset:1024
    v_mfma_f32_16x16x32_bf16 v[104:107], v[24:27], v[40:43], v[104:107]
    ds_read_b64_tr_b16 v[136:137], v54 offset:0
    v_mfma_f32_16x16x32_bf16 v[108:111], v[24:27], v[44:47], v[108:111]
    ds_read_b64_tr_b16 v[138:139], v54 offset:1024
    v_mfma_f32_16x16x32_bf16 v[124:127], v[28:31], v[44:47], v[124:127]
    ds_read_b64_tr_b16 v[140:141], v55 offset:0
    v_mfma_f32_16x16x32_bf16 v[120:123], v[28:31], v[40:43], v[120:123]
    ds_read_b64_tr_b16 v[142:143], v55 offset:1024
    v_mfma_f32_16x16x32_bf16 v[116:119], v[28:31], v[36:39], v[116:119]
    v_mfma_f32_16x16x32_bf16 v[112:115], v[28:31], v[32:35], v[112:115]
    s_waitcnt lgkmcnt(6)
    v_mfma_f32_16x16x32_bf16 v[64:67], v[128:131], v[144:147], v[64:67]
    ds_read_b128 v[32:35], v49 offset:0
    v_mfma_f32_16x16x32_bf16 v[68:71], v[128:131], v[148:151], v[68:71]
    ds_read_b128 v[36:39], v49 offset:2048
    v_mfma_f32_16x16x32_bf16 v[72:75], v[128:131], v[152:155], v[72:75]
    ds_read_b128 v[40:43], v49 offset:4096
    v_mfma_f32_16x16x32_bf16 v[76:79], v[128:131], v[156:159], v[76:79]
    ds_read_b128 v[44:47], v49 offset:6144
    s_waitcnt lgkmcnt(8)
    v_mfma_f32_16x16x32_bf16 v[92:95], v[132:135], v[156:159], v[92:95]
    ds_read_b64_tr_b16 v[16:17], v52 offset:8192
    v_mfma_f32_16x16x32_bf16 v[88:91], v[132:135], v[152:155], v[88:91]
    ds_read_b64_tr_b16 v[18:19], v52 offset:9216
    v_mfma_f32_16x16x32_bf16 v[84:87], v[132:135], v[148:151], v[84:87]
    ds_read_b64_tr_b16 v[20:21], v53 offset:8192
    v_mfma_f32_16x16x32_bf16 v[80:83], v[132:135], v[144:147], v[80:83]
    ds_read_b64_tr_b16 v[22:23], v53 offset:9216
    s_waitcnt lgkmcnt(10)
    v_mfma_f32_16x16x32_bf16 v[96:99], v[136:139], v[144:147], v[96:99]
    ds_read_b64_tr_b16 v[24:25], v54 offset:8192
    v_mfma_f32_16x16x32_bf16 v[100:103], v[136:139], v[148:151], v[100:103]
    ds_read_b64_tr_b16 v[26:27], v54 offset:9216
    v_mfma_f32_16x16x32_bf16 v[104:107], v[136:139], v[152:155], v[104:107]
    ds_read_b64_tr_b16 v[28:29], v55 offset:8192
    v_mfma_f32_16x16x32_bf16 v[108:111], v[136:139], v[156:159], v[108:111]
    ds_read_b64_tr_b16 v[30:31], v55 offset:9216
    s_waitcnt lgkmcnt(12)
    v_mfma_f32_16x16x32_bf16 v[124:127], v[140:143], v[156:159], v[124:127]
    v_mfma_f32_16x16x32_bf16 v[120:123], v[140:143], v[152:155], v[120:123]
    v_mfma_f32_16x16x32_bf16 v[116:119], v[140:143], v[148:151], v[116:119]
    v_mfma_f32_16x16x32_bf16 v[112:115], v[140:143], v[144:147], v[112:115]
    s_waitcnt lgkmcnt(6)
    v_mfma_f32_16x16x32_bf16 v[64:67], v[16:19], v[32:35], v[64:67]
    v_mfma_f32_16x16x32_bf16 v[68:71], v[16:19], v[36:39], v[68:71]
    v_mfma_f32_16x16x32_bf16 v[72:75], v[16:19], v[40:43], v[72:75]
    v_mfma_f32_16x16x32_bf16 v[76:79], v[16:19], v[44:47], v[76:79]
    s_waitcnt lgkmcnt(0)
    s_waitcnt vmcnt(0)
    s_mov_b32 s76, 0
L_nonr_11:
    v_readfirstlane_b32 s60, v60
    v_readfirstlane_b32 s61, v61
    s_cmp_eq_u32 s60, 0
    s_cbranch_scc1 L_non_10
L_nond_12:
    s_lshl_b32 s70, s63, 2
    s_add_u32 s70, s70, s56
    s_lshl_b32 s70, s70, 5
    s_add_u32 s70, s70, s62
    s_mul_i32 s70, s70, 8
    s_add_u32 s70, s70, 18087936
    v_mov_b32 v2, s60
    v_mov_b32 v3, s61
    v_mov_b32 v4, s70
    s_mov_b64 exec, 1
    buffer_store_dwordx2 v[2:3], v4, s[52:55], 0 offen sc1
    s_mov_b64 exec, -1
    s_barrier
    ds_read_b128 v[144:147], v48 offset:32768
    ds_read_b128 v[148:151], v48 offset:34816
    v_mfma_f32_16x16x32_bf16 v[92:95], v[20:23], v[44:47], v[92:95]
    ds_read_b128 v[152:155], v48 offset:36864
    v_mfma_f32_16x16x32_bf16 v[88:91], v[20:23], v[40:43], v[88:91]
    ds_read_b128 v[156:159], v48 offset:38912
    v_mfma_f32_16x16x32_bf16 v[84:87], v[20:23], v[36:39], v[84:87]
    ds_read_b64_tr_b16 v[128:129], v52 offset:32768
    v_mfma_f32_16x16x32_bf16 v[80:83], v[20:23], v[32:35], v[80:83]
    ds_read_b64_tr_b16 v[130:131], v52 offset:33792
    v_mfma_f32_16x16x32_bf16 v[96:99], v[24:27], v[32:35], v[96:99]
    ds_read_b64_tr_b16 v[132:133], v53 offset:32768
    v_mfma_f32_16x16x32_bf16 v[100:103], v[24:27], v[36:39], v[100:103]
    ds_read_b64_tr_b16 v[134:135], v53 offset:33792
    v_mfma_f32_16x16x32_bf16 v[104:107], v[24:27], v[40:43], v[104:107]
    ds_read_b64_tr_b16 v[136:137], v54 offset:32768
    v_mfma_f32_16x16x32_bf16 v[108:111], v[24:27], v[44:47], v[108:111]
    ds_read_b64_tr_b16 v[138:139], v54 offset:33792
    v_mfma_f32_16x16x32_bf16 v[124:127], v[28:31], v[44:47], v[124:127]
    ds_read_b64_tr_b16 v[140:141], v55 offset:32768
    v_mfma_f32_16x16x32_bf16 v[120:123], v[28:31], v[40:43], v[120:123]
    ds_read_b64_tr_b16 v[142:143], v55 offset:33792
    v_mfma_f32_16x16x32_bf16 v[116:119], v[28:31], v[36:39], v[116:119]
    v_mfma_f32_16x16x32_bf16 v[112:115], v[28:31], v[32:35], v[112:115]
    s_waitcnt lgkmcnt(6)
    v_mfma_f32_16x16x32_bf16 v[64:67], v[128:131], v[144:147], v[64:67]
    ds_read_b128 v[32:35], v49 offset:32768
    v_mfma_f32_16x16x32_bf16 v[68:71], v[128:131], v[148:151], v[68:71]
    ds_read_b128 v[36:39], v49 offset:34816
    v_mfma_f32_16x16x32_bf16 v[72:75], v[128:131], v[152:155], v[72:75]
    ds_read_b128 v[40:43], v49 offset:36864
    v_mfma_f32_16x16x32_bf16 v[76:79], v[128:131], v[156:159], v[76:79]
    ds_read_b128 v[44:47], v49 offset:38912
    s_waitcnt lgkmcnt(8)
    v_mfma_f32_16x16x32_bf16 v[92:95], v[132:135], v[156:159], v[92:95]
    ds_read_b64_tr_b16 v[16:17], v52 offset:40960
    v_mfma_f32_16x16x32_bf16 v[88:91], v[132:135], v[152:155], v[88:91]
    ds_read_b64_tr_b16 v[18:19], v52 offset:41984
    v_mfma_f32_16x16x32_bf16 v[84:87], v[132:135], v[148:151], v[84:87]
    ds_read_b64_tr_b16 v[20:21], v53 offset:40960
    v_mfma_f32_16x16x32_bf16 v[80:83], v[132:135], v[144:147], v[80:83]
    ds_read_b64_tr_b16 v[22:23], v53 offset:41984
    s_waitcnt lgkmcnt(10)
    v_mfma_f32_16x16x32_bf16 v[96:99], v[136:139], v[144:147], v[96:99]
    ds_read_b64_tr_b16 v[24:25], v54 offset:40960
    v_mfma_f32_16x16x32_bf16 v[100:103], v[136:139], v[148:151], v[100:103]
    ds_read_b64_tr_b16 v[26:27], v54 offset:41984
    v_mfma_f32_16x16x32_bf16 v[104:107], v[136:139], v[152:155], v[104:107]
    ds_read_b64_tr_b16 v[28:29], v55 offset:40960
    v_mfma_f32_16x16x32_bf16 v[108:111], v[136:139], v[156:159], v[108:111]
    ds_read_b64_tr_b16 v[30:31], v55 offset:41984
    s_waitcnt lgkmcnt(12)
    v_mfma_f32_16x16x32_bf16 v[124:127], v[140:143], v[156:159], v[124:127]
    v_mfma_f32_16x16x32_bf16 v[120:123], v[140:143], v[152:155], v[120:123]
    v_mfma_f32_16x16x32_bf16 v[116:119], v[140:143], v[148:151], v[116:119]
    v_mfma_f32_16x16x32_bf16 v[112:115], v[140:143], v[144:147], v[112:115]
    s_waitcnt lgkmcnt(6)
    v_mfma_f32_16x16x32_bf16 v[64:67], v[16:19], v[32:35], v[64:67]
    v_mfma_f32_16x16x32_bf16 v[68:71], v[16:19], v[36:39], v[68:71]
    v_mfma_f32_16x16x32_bf16 v[72:75], v[16:19], v[40:43], v[72:75]
    v_mfma_f32_16x16x32_bf16 v[76:79], v[16:19], v[44:47], v[76:79]
    s_waitcnt lgkmcnt(0)
    s_barrier
    ds_read_b128 v[144:147], v50 offset:0
    ds_read_b128 v[148:151], v50 offset:2048
    v_mfma_f32_16x16x32_bf16 v[92:95], v[20:23], v[44:47], v[92:95]
    ds_read_b128 v[152:155], v50 offset:4096
    v_mfma_f32_16x16x32_bf16 v[88:91], v[20:23], v[40:43], v[88:91]
    ds_read_b128 v[156:159], v50 offset:6144
    v_mfma_f32_16x16x32_bf16 v[84:87], v[20:23], v[36:39], v[84:87]
    ds_read_b64_tr_b16 v[128:129], v56 offset:0
    v_mfma_f32_16x16x32_bf16 v[80:83], v[20:23], v[32:35], v[80:83]
    ds_read_b64_tr_b16 v[130:131], v56 offset:1024
    v_mfma_f32_16x16x32_bf16 v[96:99], v[24:27], v[32:35], v[96:99]
    ds_read_b64_tr_b16 v[132:133], v57 offset:0
    v_mfma_f32_16x16x32_bf16 v[100:103], v[24:27], v[36:39], v[100:103]
    ds_read_b64_tr_b16 v[134:135], v57 offset:1024
    v_mfma_f32_16x16x32_bf16 v[104:107], v[24:27], v[40:43], v[104:107]
    ds_read_b64_tr_b16 v[136:137], v58 offset:0
    v_mfma_f32_16x16x32_bf16 v[108:111], v[24:27], v[44:47], v[108:111]
    ds_read_b64_tr_b16 v[138:139], v58 offset:1024
    v_mfma_f32_16x16x32_bf16 v[124:127], v[28:31], v[44:47], v[124:127]
    ds_read_b64_tr_b16 v[140:141], v59 offset:0
    v_mfma_f32_16x16x32_bf16 v[120:123], v[28:31], v[40:43], v[120:123]
    ds_read_b64_tr_b16 v[142:143], v59 offset:1024
    v_mfma_f32_16x16x32_bf16 v[116:119], v[28:31], v[36:39], v[116:119]
    v_mfma_f32_16x16x32_bf16 v[112:115], v[28:31], v[32:35], v[112:115]
    s_waitcnt lgkmcnt(6)
    v_mfma_f32_16x16x32_bf16 v[64:67], v[128:131], v[144:147], v[64:67]
    ds_read_b128 v[32:35], v51 offset:0
    v_mfma_f32_16x16x32_bf16 v[68:71], v[128:131], v[148:151], v[68:71]
    ds_read_b128 v[36:39], v51 offset:2048
    v_mfma_f32_16x16x32_bf16 v[72:75], v[128:131], v[152:155], v[72:75]
    ds_read_b128 v[40:43], v51 offset:4096
    v_mfma_f32_16x16x32_bf16 v[76:79], v[128:131], v[156:159], v[76:79]
    ds_read_b128 v[44:47], v51 offset:6144
    s_waitcnt lgkmcnt(8)
    v_mfma_f32_16x16x32_bf16 v[92:95], v[132:135], v[156:159], v[92:95]
    ds_read_b64_tr_b16 v[16:17], v56 offset:8192
    v_mfma_f32_16x16x32_bf16 v[88:91], v[132:135], v[152:155], v[88:91]
    ds_read_b64_tr_b16 v[18:19], v56 offset:9216
    v_mfma_f32_16x16x32_bf16 v[84:87], v[132:135], v[148:151], v[84:87]
    ds_read_b64_tr_b16 v[20:21], v57 offset:8192
    v_mfma_f32_16x16x32_bf16 v[80:83], v[132:135], v[144:147], v[80:83]
    ds_read_b64_tr_b16 v[22:23], v57 offset:9216
    s_waitcnt lgkmcnt(10)
    v_mfma_f32_16x16x32_bf16 v[96:99], v[136:139], v[144:147], v[96:99]
    ds_read_b64_tr_b16 v[24:25], v58 offset:8192
    v_mfma_f32_16x16x32_bf16 v[100:103], v[136:139], v[148:151], v[100:103]
    ds_read_b64_tr_b16 v[26:27], v58 offset:9216
    v_mfma_f32_16x16x32_bf16 v[104:107], v[136:139], v[152:155], v[104:107]
    ds_read_b64_tr_b16 v[28:29], v59 offset:8192
    v_mfma_f32_16x16x32_bf16 v[108:111], v[136:139], v[156:159], v[108:111]
    ds_read_b64_tr_b16 v[30:31], v59 offset:9216
    s_waitcnt lgkmcnt(12)
    v_mfma_f32_16x16x32_bf16 v[124:127], v[140:143], v[156:159], v[124:127]
    v_mfma_f32_16x16x32_bf16 v[120:123], v[140:143], v[152:155], v[120:123]
    v_mfma_f32_16x16x32_bf16 v[116:119], v[140:143], v[148:151], v[116:119]
    v_mfma_f32_16x16x32_bf16 v[112:115], v[140:143], v[144:147], v[112:115]
    s_waitcnt lgkmcnt(6)
    v_mfma_f32_16x16x32_bf16 v[64:67], v[16:19], v[32:35], v[64:67]
    v_mfma_f32_16x16x32_bf16 v[68:71], v[16:19], v[36:39], v[68:71]
    v_mfma_f32_16x16x32_bf16 v[72:75], v[16:19], v[40:43], v[72:75]
    v_mfma_f32_16x16x32_bf16 v[76:79], v[16:19], v[44:47], v[76:79]
    s_waitcnt lgkmcnt(0)
    s_barrier
    ds_read_b128 v[144:147], v48 offset:0
    ds_read_b128 v[148:151], v48 offset:2048
    v_mfma_f32_16x16x32_bf16 v[92:95], v[20:23], v[44:47], v[92:95]
    ds_read_b128 v[152:155], v48 offset:4096
    v_mfma_f32_16x16x32_bf16 v[88:91], v[20:23], v[40:43], v[88:91]
    ds_read_b128 v[156:159], v48 offset:6144
    v_mfma_f32_16x16x32_bf16 v[84:87], v[20:23], v[36:39], v[84:87]
    ds_read_b64_tr_b16 v[128:129], v52 offset:0
    v_mfma_f32_16x16x32_bf16 v[80:83], v[20:23], v[32:35], v[80:83]
    ds_read_b64_tr_b16 v[130:131], v52 offset:1024
    v_mfma_f32_16x16x32_bf16 v[96:99], v[24:27], v[32:35], v[96:99]
    ds_read_b64_tr_b16 v[132:133], v53 offset:0
    v_mfma_f32_16x16x32_bf16 v[100:103], v[24:27], v[36:39], v[100:103]
    ds_read_b64_tr_b16 v[134:135], v53 offset:1024
    v_mfma_f32_16x16x32_bf16 v[104:107], v[24:27], v[40:43], v[104:107]
    ds_read_b64_tr_b16 v[136:137], v54 offset:0
    v_mfma_f32_16x16x32_bf16 v[108:111], v[24:27], v[44:47], v[108:111]
    ds_read_b64_tr_b16 v[138:139], v54 offset:1024
    v_mfma_f32_16x16x32_bf16 v[124:127], v[28:31], v[44:47], v[124:127]
    ds_read_b64_tr_b16 v[140:141], v55 offset:0
    v_mfma_f32_16x16x32_bf16 v[120:123], v[28:31], v[40:43], v[120:123]
    ds_read_b64_tr_b16 v[142:143], v55 offset:1024
    v_mfma_f32_16x16x32_bf16 v[116:119], v[28:31], v[36:39], v[116:119]
    v_mfma_f32_16x16x32_bf16 v[112:115], v[28:31], v[32:35], v[112:115]
    s_waitcnt lgkmcnt(6)
    v_mfma_f32_16x16x32_bf16 v[64:67], v[128:131], v[144:147], v[64:67]
    ds_read_b128 v[32:35], v49 offset:0
    v_mfma_f32_16x16x32_bf16 v[68:71], v[128:131], v[148:151], v[68:71]
    ds_read_b128 v[36:39], v49 offset:2048
    v_mfma_f32_16x16x32_bf16 v[72:75], v[128:131], v[152:155], v[72:75]
    ds_read_b128 v[40:43], v49 offset:4096
    v_mfma_f32_16x16x32_bf16 v[76:79], v[128:131], v[156:159], v[76:79]
    ds_read_b128 v[44:47], v49 offset:6144
    s_waitcnt lgkmcnt(8)
    v_mfma_f32_16x16x32_bf16 v[92:95], v[132:135], v[156:159], v[92:95]
    ds_read_b64_tr_b16 v[16:17], v52 offset:8192
    v_mfma_f32_16x16x32_bf16 v[88:91], v[132:135], v[152:155], v[88:91]
    ds_read_b64_tr_b16 v[18:19], v52 offset:9216
    v_mfma_f32_16x16x32_bf16 v[84:87], v[132:135], v[148:151], v[84:87]
    ds_read_b64_tr_b16 v[20:21], v53 offset:8192
    v_mfma_f32_16x16x32_bf16 v[80:83], v[132:135], v[144:147], v[80:83]
    ds_read_b64_tr_b16 v[22:23], v53 offset:9216
    s_waitcnt lgkmcnt(10)
    v_mfma_f32_16x16x32_bf16 v[96:99], v[136:139], v[144:147], v[96:99]
    ds_read_b64_tr_b16 v[24:25], v54 offset:8192
    v_mfma_f32_16x16x32_bf16 v[100:103], v[136:139], v[148:151], v[100:103]
    ds_read_b64_tr_b16 v[26:27], v54 offset:9216
    v_mfma_f32_16x16x32_bf16 v[104:107], v[136:139], v[152:155], v[104:107]
    ds_read_b64_tr_b16 v[28:29], v55 offset:8192
    v_mfma_f32_16x16x32_bf16 v[108:111], v[136:139], v[156:159], v[108:111]
    ds_read_b64_tr_b16 v[30:31], v55 offset:9216
    s_waitcnt lgkmcnt(12)
    v_mfma_f32_16x16x32_bf16 v[124:127], v[140:143], v[156:159], v[124:127]
    v_mfma_f32_16x16x32_bf16 v[120:123], v[140:143], v[152:155], v[120:123]
    v_mfma_f32_16x16x32_bf16 v[116:119], v[140:143], v[148:151], v[116:119]
    v_mfma_f32_16x16x32_bf16 v[112:115], v[140:143], v[144:147], v[112:115]
    s_waitcnt lgkmcnt(6)
    v_mfma_f32_16x16x32_bf16 v[64:67], v[16:19], v[32:35], v[64:67]
    v_mfma_f32_16x16x32_bf16 v[68:71], v[16:19], v[36:39], v[68:71]
    v_mfma_f32_16x16x32_bf16 v[72:75], v[16:19], v[40:43], v[72:75]
    v_mfma_f32_16x16x32_bf16 v[76:79], v[16:19], v[44:47], v[76:79]
    s_waitcnt lgkmcnt(0)
    s_barrier
    ds_read_b128 v[144:147], v48 offset:32768
    ds_read_b128 v[148:151], v48 offset:34816
    v_mfma_f32_16x16x32_bf16 v[92:95], v[20:23], v[44:47], v[92:95]
    ds_read_b128 v[152:155], v48 offset:36864
    v_mfma_f32_16x16x32_bf16 v[88:91], v[20:23], v[40:43], v[88:91]
    ds_read_b128 v[156:159], v48 offset:38912
    v_mfma_f32_16x16x32_bf16 v[84:87], v[20:23], v[36:39], v[84:87]
    ds_read_b64_tr_b16 v[128:129], v52 offset:32768
    v_mfma_f32_16x16x32_bf16 v[80:83], v[20:23], v[32:35], v[80:83]
    ds_read_b64_tr_b16 v[130:131], v52 offset:33792
    v_mfma_f32_16x16x32_bf16 v[96:99], v[24:27], v[32:35], v[96:99]
    ds_read_b64_tr_b16 v[132:133], v53 offset:32768
    v_mfma_f32_16x16x32_bf16 v[100:103], v[24:27], v[36:39], v[100:103]
    ds_read_b64_tr_b16 v[134:135], v53 offset:33792
    v_mfma_f32_16x16x32_bf16 v[104:107], v[24:27], v[40:43], v[104:107]
    ds_read_b64_tr_b16 v[136:137], v54 offset:32768
    v_mfma_f32_16x16x32_bf16 v[108:111], v[24:27], v[44:47], v[108:111]
    ds_read_b64_tr_b16 v[138:139], v54 offset:33792
    v_mfma_f32_16x16x32_bf16 v[124:127], v[28:31], v[44:47], v[124:127]
    ds_read_b64_tr_b16 v[140:141], v55 offset:32768
    v_mfma_f32_16x16x32_bf16 v[120:123], v[28:31], v[40:43], v[120:123]
    ds_read_b64_tr_b16 v[142:143], v55 offset:33792
    v_mfma_f32_16x16x32_bf16 v[116:119], v[28:31], v[36:39], v[116:119]
    v_mfma_f32_16x16x32_bf16 v[112:115], v[28:31], v[32:35], v[112:115]
    s_waitcnt lgkmcnt(6)
    v_mfma_f32_16x16x32_bf16 v[64:67], v[128:131], v[144:147], v[64:67]
    ds_read_b128 v[32:35], v49 offset:32768
    v_mfma_f32_16x16x32_bf16 v[68:71], v[128:131], v[148:151], v[68:71]
    ds_read_b128 v[36:39], v49 offset:34816
    v_mfma_f32_16x16x32_bf16 v[72:75], v[128:131], v[152:155], v[72:75]
    ds_read_b128 v[40:43], v49 offset:36864
    v_mfma_f32_16x16x32_bf16 v[76:79], v[128:131], v[156:159], v[76:79]
    ds_read_b128 v[44:47], v49 offset:38912
    s_waitcnt lgkmcnt(8)
    v_mfma_f32_16x16x32_bf16 v[92:95], v[132:135], v[156:159], v[92:95]
    ds_read_b64_tr_b16 v[16:17], v52 offset:40960
    v_mfma_f32_16x16x32_bf16 v[88:91], v[132:135], v[152:155], v[88:91]
    ds_read_b64_tr_b16 v[18:19], v52 offset:41984
    v_mfma_f32_16x16x32_bf16 v[84:87], v[132:135], v[148:151], v[84:87]
    ds_read_b64_tr_b16 v[20:21], v53 offset:40960
    v_mfma_f32_16x16x32_bf16 v[80:83], v[132:135], v[144:147], v[80:83]
    ds_read_b64_tr_b16 v[22:23], v53 offset:41984
    s_waitcnt lgkmcnt(10)
    v_mfma_f32_16x16x32_bf16 v[96:99], v[136:139], v[144:147], v[96:99]
    ds_read_b64_tr_b16 v[24:25], v54 offset:40960
    v_mfma_f32_16x16x32_bf16 v[100:103], v[136:139], v[148:151], v[100:103]
    ds_read_b64_tr_b16 v[26:27], v54 offset:41984
    v_mfma_f32_16x16x32_bf16 v[104:107], v[136:139], v[152:155], v[104:107]
    ds_read_b64_tr_b16 v[28:29], v55 offset:40960
    v_mfma_f32_16x16x32_bf16 v[108:111], v[136:139], v[156:159], v[108:111]
    ds_read_b64_tr_b16 v[30:31], v55 offset:41984
    s_waitcnt lgkmcnt(12)
    v_mfma_f32_16x16x32_bf16 v[124:127], v[140:143], v[156:159], v[124:127]
    v_mfma_f32_16x16x32_bf16 v[120:123], v[140:143], v[152:155], v[120:123]
    v_mfma_f32_16x16x32_bf16 v[116:119], v[140:143], v[148:151], v[116:119]
    v_mfma_f32_16x16x32_bf16 v[112:115], v[140:143], v[144:147], v[112:115]
    s_waitcnt lgkmcnt(6)
    v_mfma_f32_16x16x32_bf16 v[64:67], v[16:19], v[32:35], v[64:67]
    v_mfma_f32_16x16x32_bf16 v[68:71], v[16:19], v[36:39], v[68:71]
    v_mfma_f32_16x16x32_bf16 v[72:75], v[16:19], v[40:43], v[72:75]
    v_mfma_f32_16x16x32_bf16 v[76:79], v[16:19], v[44:47], v[76:79]
    s_waitcnt lgkmcnt(0)
    s_barrier
    ds_read_b128 v[144:147], v50 offset:0
    ds_read_b128 v[148:151], v50 offset:2048
    v_mfma_f32_16x16x32_bf16 v[92:95], v[20:23], v[44:47], v[92:95]
    ds_read_b128 v[152:155], v50 offset:4096
    v_mfma_f32_16x16x32_bf16 v[88:91], v[20:23], v[40:43], v[88:91]
    ds_read_b128 v[156:159], v50 offset:6144
    v_mfma_f32_16x16x32_bf16 v[84:87], v[20:23], v[36:39], v[84:87]
    ds_read_b64_tr_b16 v[128:129], v56 offset:0
    v_mfma_f32_16x16x32_bf16 v[80:83], v[20:23], v[32:35], v[80:83]
    ds_read_b64_tr_b16 v[130:131], v56 offset:1024
    v_mfma_f32_16x16x32_bf16 v[96:99], v[24:27], v[32:35], v[96:99]
    ds_read_b64_tr_b16 v[132:133], v57 offset:0
    v_mfma_f32_16x16x32_bf16 v[100:103], v[24:27], v[36:39], v[100:103]
    ds_read_b64_tr_b16 v[134:135], v57 offset:1024
    v_mfma_f32_16x16x32_bf16 v[104:107], v[24:27], v[40:43], v[104:107]
    ds_read_b64_tr_b16 v[136:137], v58 offset:0
    v_mfma_f32_16x16x32_bf16 v[108:111], v[24:27], v[44:47], v[108:111]
    ds_read_b64_tr_b16 v[138:139], v58 offset:1024
    v_mfma_f32_16x16x32_bf16 v[124:127], v[28:31], v[44:47], v[124:127]
    ds_read_b64_tr_b16 v[140:141], v59 offset:0
    v_mfma_f32_16x16x32_bf16 v[120:123], v[28:31], v[40:43], v[120:123]
    ds_read_b64_tr_b16 v[142:143], v59 offset:1024
    v_mfma_f32_16x16x32_bf16 v[116:119], v[28:31], v[36:39], v[116:119]
    v_mfma_f32_16x16x32_bf16 v[112:115], v[28:31], v[32:35], v[112:115]
    s_waitcnt lgkmcnt(6)
    v_mfma_f32_16x16x32_bf16 v[64:67], v[128:131], v[144:147], v[64:67]
    ds_read_b128 v[32:35], v51 offset:0
    v_mfma_f32_16x16x32_bf16 v[68:71], v[128:131], v[148:151], v[68:71]
    ds_read_b128 v[36:39], v51 offset:2048
    v_mfma_f32_16x16x32_bf16 v[72:75], v[128:131], v[152:155], v[72:75]
    ds_read_b128 v[40:43], v51 offset:4096
    v_mfma_f32_16x16x32_bf16 v[76:79], v[128:131], v[156:159], v[76:79]
    ds_read_b128 v[44:47], v51 offset:6144
    s_waitcnt lgkmcnt(8)
    v_mfma_f32_16x16x32_bf16 v[92:95], v[132:135], v[156:159], v[92:95]
    ds_read_b64_tr_b16 v[16:17], v56 offset:8192
    v_mfma_f32_16x16x32_bf16 v[88:91], v[132:135], v[152:155], v[88:91]
    ds_read_b64_tr_b16 v[18:19], v56 offset:9216
    v_mfma_f32_16x16x32_bf16 v[84:87], v[132:135], v[148:151], v[84:87]
    ds_read_b64_tr_b16 v[20:21], v57 offset:8192
    v_mfma_f32_16x16x32_bf16 v[80:83], v[132:135], v[144:147], v[80:83]
    ds_read_b64_tr_b16 v[22:23], v57 offset:9216
    s_waitcnt lgkmcnt(10)
    v_mfma_f32_16x16x32_bf16 v[96:99], v[136:139], v[144:147], v[96:99]
    ds_read_b64_tr_b16 v[24:25], v58 offset:8192
    v_mfma_f32_16x16x32_bf16 v[100:103], v[136:139], v[148:151], v[100:103]
    ds_read_b64_tr_b16 v[26:27], v58 offset:9216
    v_mfma_f32_16x16x32_bf16 v[104:107], v[136:139], v[152:155], v[104:107]
    ds_read_b64_tr_b16 v[28:29], v59 offset:8192
    v_mfma_f32_16x16x32_bf16 v[108:111], v[136:139], v[156:159], v[108:111]
    ds_read_b64_tr_b16 v[30:31], v59 offset:9216
    s_waitcnt lgkmcnt(12)
    v_mfma_f32_16x16x32_bf16 v[124:127], v[140:143], v[156:159], v[124:127]
    v_mfma_f32_16x16x32_bf16 v[120:123], v[140:143], v[152:155], v[120:123]
    v_mfma_f32_16x16x32_bf16 v[116:119], v[140:143], v[148:151], v[116:119]
    v_mfma_f32_16x16x32_bf16 v[112:115], v[140:143], v[144:147], v[112:115]
    s_waitcnt lgkmcnt(6)
    v_mfma_f32_16x16x32_bf16 v[64:67], v[16:19], v[32:35], v[64:67]
    v_mfma_f32_16x16x32_bf16 v[68:71], v[16:19], v[36:39], v[68:71]
    v_mfma_f32_16x16x32_bf16 v[72:75], v[16:19], v[40:43], v[72:75]
    v_mfma_f32_16x16x32_bf16 v[76:79], v[16:19], v[44:47], v[76:79]
    s_waitcnt lgkmcnt(0)
    s_barrier
    ds_read_b128 v[144:147], v48 offset:0
    ds_read_b128 v[148:151], v48 offset:2048
    v_mfma_f32_16x16x32_bf16 v[92:95], v[20:23], v[44:47], v[92:95]
    ds_read_b128 v[152:155], v48 offset:4096
    v_mfma_f32_16x16x32_bf16 v[88:91], v[20:23], v[40:43], v[88:91]
    ds_read_b128 v[156:159], v48 offset:6144
    v_mfma_f32_16x16x32_bf16 v[84:87], v[20:23], v[36:39], v[84:87]
    ds_read_b64_tr_b16 v[128:129], v52 offset:0
    v_mfma_f32_16x16x32_bf16 v[80:83], v[20:23], v[32:35], v[80:83]
    ds_read_b64_tr_b16 v[130:131], v52 offset:1024
    v_mfma_f32_16x16x32_bf16 v[96:99], v[24:27], v[32:35], v[96:99]
    ds_read_b64_tr_b16 v[132:133], v53 offset:0
    v_mfma_f32_16x16x32_bf16 v[100:103], v[24:27], v[36:39], v[100:103]
    ds_read_b64_tr_b16 v[134:135], v53 offset:1024
    v_mfma_f32_16x16x32_bf16 v[104:107], v[24:27], v[40:43], v[104:107]
    ds_read_b64_tr_b16 v[136:137], v54 offset:0
    v_mfma_f32_16x16x32_bf16 v[108:111], v[24:27], v[44:47], v[108:111]
    ds_read_b64_tr_b16 v[138:139], v54 offset:1024
    v_mfma_f32_16x16x32_bf16 v[124:127], v[28:31], v[44:47], v[124:127]
    ds_read_b64_tr_b16 v[140:141], v55 offset:0
    v_mfma_f32_16x16x32_bf16 v[120:123], v[28:31], v[40:43], v[120:123]
    ds_read_b64_tr_b16 v[142:143], v55 offset:1024
    v_mfma_f32_16x16x32_bf16 v[116:119], v[28:31], v[36:39], v[116:119]
    v_mfma_f32_16x16x32_bf16 v[112:115], v[28:31], v[32:35], v[112:115]
    s_waitcnt lgkmcnt(6)
    v_mfma_f32_16x16x32_bf16 v[64:67], v[128:131], v[144:147], v[64:67]
    ds_read_b128 v[32:35], v49 offset:0
    v_mfma_f32_16x16x32_bf16 v[68:71], v[128:131], v[148:151], v[68:71]
    ds_read_b128 v[36:39], v49 offset:2048
    v_mfma_f32_16x16x32_bf16 v[72:75], v[128:131], v[152:155], v[72:75]
    ds_read_b128 v[40:43], v49 offset:4096
    v_mfma_f32_16x16x32_bf16 v[76:79], v[128:131], v[156:159], v[76:79]
    ds_read_b128 v[44:47], v49 offset:6144
    s_waitcnt lgkmcnt(8)
    v_mfma_f32_16x16x32_bf16 v[92:95], v[132:135], v[156:159], v[92:95]
    ds_read_b64_tr_b16 v[16:17], v52 offset:8192
    v_mfma_f32_16x16x32_bf16 v[88:91], v[132:135], v[152:155], v[88:91]
    ds_read_b64_tr_b16 v[18:19], v52 offset:9216
    v_mfma_f32_16x16x32_bf16 v[84:87], v[132:135], v[148:151], v[84:87]
    ds_read_b64_tr_b16 v[20:21], v53 offset:8192
    v_mfma_f32_16x16x32_bf16 v[80:83], v[132:135], v[144:147], v[80:83]
    ds_read_b64_tr_b16 v[22:23], v53 offset:9216
    s_waitcnt lgkmcnt(10)
    v_mfma_f32_16x16x32_bf16 v[96:99], v[136:139], v[144:147], v[96:99]
    ds_read_b64_tr_b16 v[24:25], v54 offset:8192
    v_mfma_f32_16x16x32_bf16 v[100:103], v[136:139], v[148:151], v[100:103]
    ds_read_b64_tr_b16 v[26:27], v54 offset:9216
    v_mfma_f32_16x16x32_bf16 v[104:107], v[136:139], v[152:155], v[104:107]
    ds_read_b64_tr_b16 v[28:29], v55 offset:8192
    v_mfma_f32_16x16x32_bf16 v[108:111], v[136:139], v[156:159], v[108:111]
    ds_read_b64_tr_b16 v[30:31], v55 offset:9216
    s_waitcnt lgkmcnt(12)
    v_mfma_f32_16x16x32_bf16 v[124:127], v[140:143], v[156:159], v[124:127]
    v_mfma_f32_16x16x32_bf16 v[120:123], v[140:143], v[152:155], v[120:123]
    v_mfma_f32_16x16x32_bf16 v[116:119], v[140:143], v[148:151], v[116:119]
    v_mfma_f32_16x16x32_bf16 v[112:115], v[140:143], v[144:147], v[112:115]
    s_waitcnt lgkmcnt(6)
    v_mfma_f32_16x16x32_bf16 v[64:67], v[16:19], v[32:35], v[64:67]
    v_mfma_f32_16x16x32_bf16 v[68:71], v[16:19], v[36:39], v[68:71]
    v_mfma_f32_16x16x32_bf16 v[72:75], v[16:19], v[40:43], v[72:75]
    v_mfma_f32_16x16x32_bf16 v[76:79], v[16:19], v[44:47], v[76:79]
    s_waitcnt lgkmcnt(0)
    s_barrier
    ds_read_b128 v[144:147], v48 offset:32768
    ds_read_b128 v[148:151], v48 offset:34816
    v_mfma_f32_16x16x32_bf16 v[92:95], v[20:23], v[44:47], v[92:95]
    s_and_b32 s70, s56, 1
    s_lshr_b32 s71, s56, 1
    ds_read_b128 v[152:155], v48 offset:36864
    ds_read_b128 v[156:159], v48 offset:38912
    v_mfma_f32_16x16x32_bf16 v[88:91], v[20:23], v[40:43], v[88:91]
    s_lshl_b32 s72, s65, 1
    s_add_u32 s72, s72, s70
    ds_read_b64_tr_b16 v[128:129], v52 offset:32768
    ds_read_b64_tr_b16 v[130:131], v52 offset:33792
    v_mfma_f32_16x16x32_bf16 v[84:87], v[20:23], v[36:39], v[84:87]
    s_lshl_b32 s73, s64, 1
    s_add_u32 s73, s73, s71
    ds_read_b64_tr_b16 v[16:17], v52 offset:40960
    ds_read_b64_tr_b16 v[18:19], v52 offset:41984
    v_mfma_f32_16x16x32_bf16 v[80:83], v[20:23], v[32:35], v[80:83]
    s_lshl_b32 s82, s72, 18
    s_lshl_b32 s74, s73, 10
    ds_read_b128 v[160:163], v49 offset:32768
    ds_read_b128 v[164:167], v49 offset:34816
    v_mfma_f32_16x16x32_bf16 v[96:99], v[24:27], v[32:35], v[96:99]
    s_add_u32 s82, s82, s74
    s_lshl_b32 s83, s72, 5
    ds_read_b128 v[168:171], v49 offset:36864
    ds_read_b128 v[172:175], v49 offset:38912
    v_mfma_f32_16x16x32_bf16 v[100:103], v[24:27], v[36:39], v[100:103]
    s_add_u32 s83, s83, s73
    s_mul_i32 s83, s83, 128
    ds_read_b64_tr_b16 v[132:133], v53 offset:32768
    ds_read_b64_tr_b16 v[134:135], v53 offset:33792
    v_mfma_f32_16x16x32_bf16 v[104:107], v[24:27], v[40:43], v[104:107]
    s_add_u32 s83, s83, 17825792
    v_and_b32 v2, 31, v1
    ds_read_b64_tr_b16 v[20:21], v53 offset:40960
    ds_read_b64_tr_b16 v[22:23], v53 offset:41984
    v_mfma_f32_16x16x32_bf16 v[108:111], v[24:27], v[44:47], v[108:111]
    v_lshrrev_b32 v3, 5, v1
    v_lshlrev_b32 v2, 4, v2
    ds_read_b64_tr_b16 v[136:137], v54 offset:32768
    ds_read_b64_tr_b16 v[138:139], v54 offset:33792
    v_mfma_f32_16x16x32_bf16 v[124:127], v[28:31], v[44:47], v[124:127]
    v_lshl_add_u32 v2, v3, 15, v2
    s_mov_b32 s72, 0x3ea52b5c
    ds_read_b64_tr_b16 v[24:25], v54 offset:40960
    ds_read_b64_tr_b16 v[26:27], v54 offset:41984
    v_mfma_f32_16x16x32_bf16 v[120:123], v[28:31], v[40:43], v[120:123]
    s_mov_b32 s73, 0x3ea52b5c
    s_cmp_lt_u32 s65, 5
    v_mfma_f32_16x16x32_bf16 v[116:119], v[28:31], v[36:39], v[116:119]
    s_cselect_b32 s72, s72, 1.0
    s_cselect_b32 s73, s73, 1.0
    v_mfma_f32_16x16x32_bf16 v[112:115], v[28:31], v[32:35], v[112:115]
    ds_read_b64_tr_b16 v[140:141], v55 offset:32768
    ds_read_b64_tr_b16 v[142:143], v55 offset:33792
    ds_read_b64_tr_b16 v[28:29], v55 offset:40960
    ds_read_b64_tr_b16 v[30:31], v55 offset:41984
    s_waitcnt lgkmcnt(12)
    v_mfma_f32_16x16x32_bf16 v[64:67], v[128:131], v[144:147], v[64:67]
    v_mfma_f32_16x16x32_bf16 v[68:71], v[128:131], v[148:151], v[68:71]
    v_mfma_f32_16x16x32_bf16 v[72:75], v[128:131], v[152:155], v[72:75]
    v_mfma_f32_16x16x32_bf16 v[76:79], v[128:131], v[156:159], v[76:79]
    v_mfma_f32_16x16x32_bf16 v[64:67], v[16:19], v[160:163], v[64:67]
    v_mfma_f32_16x16x32_bf16 v[68:71], v[16:19], v[164:167], v[68:71]
    v_mfma_f32_16x16x32_bf16 v[72:75], v[16:19], v[168:171], v[72:75]
    v_mfma_f32_16x16x32_bf16 v[76:79], v[16:19], v[172:175], v[76:79]
    s_waitcnt lgkmcnt(8)
    v_mfma_f32_16x16x32_bf16 v[80:83], v[132:135], v[144:147], v[80:83]
    v_mfma_f32_16x16x32_bf16 v[84:87], v[132:135], v[148:151], v[84:87]
    s_add_u32 s70, s82, 0
    s_nop 0
    v_mul_f32 v64, s72, v64
    v_mul_f32 v65, s72, v65
    v_mul_f32 v66, s72, v66
    v_mul_f32 v67, s72, v67
    v_mfma_f32_16x16x32_bf16 v[88:91], v[132:135], v[152:155], v[88:91]
    v_mul_f32 v68, s72, v68
    v_mul_f32 v69, s72, v69
    v_mul_f32 v70, s72, v70
    v_mul_f32 v71, s72, v71
    v_cvt_pk_bf16_f32 v4, v64, v65
    v_mfma_f32_16x16x32_bf16 v[92:95], v[132:135], v[156:159], v[92:95]
    v_cvt_pk_bf16_f32 v5, v66, v67
    v_cvt_pk_bf16_f32 v6, v68, v69
    v_cvt_pk_bf16_f32 v7, v70, v71
    s_nop 0
    v_permlane16_swap_b32 v4, v6
    v_permlane16_swap_b32 v5, v7
    v_mfma_f32_16x16x32_bf16 v[80:83], v[20:23], v[160:163], v[80:83]
    buffer_store_dwordx4 v[4:7], v2, s[52:55], s70 offen offset:0 sc1
    v_mul_f32 v72, s72, v72
    v_mul_f32 v73, s72, v73
    v_mul_f32 v74, s72, v74
    v_mul_f32 v75, s72, v75
    v_mfma_f32_16x16x32_bf16 v[84:87], v[20:23], v[164:167], v[84:87]
    v_mul_f32 v76, s72, v76
    v_mul_f32 v77, s72, v77
    v_mul_f32 v78, s72, v78
    v_mul_f32 v79, s72, v79
    v_cvt_pk_bf16_f32 v8, v72, v73
    v_mfma_f32_16x16x32_bf16 v[88:91], v[20:23], v[168:171], v[88:91]
    v_cvt_pk_bf16_f32 v9, v74, v75
    v_cvt_pk_bf16_f32 v10, v76, v77
    v_cvt_pk_bf16_f32 v11, v78, v79
    s_nop 0
    v_permlane16_swap_b32 v8, v10
    v_permlane16_swap_b32 v9, v11
    v_mfma_f32_16x16x32_bf16 v[92:95], v[20:23], v[172:175], v[92:95]
    buffer_store_dwordx4 v[8:11], v2, s[52:55], s70 offen offset:512 sc1
    s_waitcnt lgkmcnt(4)
    v_mfma_f32_16x16x32_bf16 v[96:99], v[136:139], v[144:147], v[96:99]
    v_mfma_f32_16x16x32_bf16 v[100:103], v[136:139], v[148:151], v[100:103]
    s_add_u32 s70, s82, 65536
    v_mul_f32 v80, s72, v80
    v_mul_f32 v81, s72, v81
    v_mul_f32 v82, s72, v82
    v_mul_f32 v83, s72, v83
    v_mfma_f32_16x16x32_bf16 v[104:107], v[136:139], v[152:155], v[104:107]
    v_mul_f32 v84, s72, v84
    v_mul_f32 v85, s72, v85
    v_mul_f32 v86, s72, v86
    v_mul_f32 v87, s72, v87
    v_cvt_pk_bf16_f32 v176, v80, v81
    v_mfma_f32_16x16x32_bf16 v[108:111], v[136:139], v[156:159], v[108:111]
    v_cvt_pk_bf16_f32 v177, v82, v83
    v_cvt_pk_bf16_f32 v178, v84, v85
    v_cvt_pk_bf16_f32 v179, v86, v87
    s_nop 0
    v_permlane16_swap_b32 v176, v178
    v_permlane16_swap_b32 v177, v179
    v_mfma_f32_16x16x32_bf16 v[96:99], v[24:27], v[160:163], v[96:99]
    buffer_store_dwordx4 v[176:179], v2, s[52:55], s70 offen offset:0 sc1
    v_mul_f32 v88, s72, v88
    v_mul_f32 v89, s72, v89
    v_mul_f32 v90, s72, v90
    v_mul_f32 v91, s72, v91
    v_mfma_f32_16x16x32_bf16 v[100:103], v[24:27], v[164:167], v[100:103]
    v_mul_f32 v92, s72, v92
    v_mul_f32 v93, s72, v93
    v_mul_f32 v94, s72, v94
    v_mul_f32 v95, s72, v95
    v_cvt_pk_bf16_f32 v48, v88, v89
    v_mfma_f32_16x16x32_bf16 v[104:107], v[24:27], v[168:171], v[104:107]
    v_cvt_pk_bf16_f32 v49, v90, v91
    v_cvt_pk_bf16_f32 v50, v92, v93
    v_cvt_pk_bf16_f32 v51, v94, v95
    s_nop 0
    v_permlane16_swap_b32 v48, v50
    v_permlane16_swap_b32 v49, v51
    v_mfma_f32_16x16x32_bf16 v[108:111], v[24:27], v[172:175], v[108:111]
    buffer_store_dwordx4 v[48:51], v2, s[52:55], s70 offen offset:512 sc1
    s_waitcnt lgkmcnt(0)
    v_mfma_f32_16x16x32_bf16 v[112:115], v[140:143], v[144:147], v[112:115]
    v_mfma_f32_16x16x32_bf16 v[116:119], v[140:143], v[148:151], v[116:119]
    s_add_u32 s70, s82, 131072
    v_mul_f32 v96, s72, v96
    v_mul_f32 v97, s72, v97
    v_mul_f32 v98, s72, v98
    v_mul_f32 v99, s72, v99
    v_mfma_f32_16x16x32_bf16 v[120:123], v[140:143], v[152:155], v[120:123]
    v_mul_f32 v100, s72, v100
    v_mul_f32 v101, s72, v101
    v_mul_f32 v102, s72, v102
    v_mul_f32 v103, s72, v103
    v_cvt_pk_bf16_f32 v4, v96, v97
    v_mfma_f32_16x16x32_bf16 v[124:127], v[140:143], v[156:159], v[124:127]
    v_cvt_pk_bf16_f32 v5, v98, v99
    v_cvt_pk_bf16_f32 v6, v100, v101
    v_cvt_pk_bf16_f32 v7, v102, v103
    s_nop 0
    v_permlane16_swap_b32 v4, v6
    v_permlane16_swap_b32 v5, v7
    v_mfma_f32_16x16x32_bf16 v[112:115], v[28:31], v[160:163], v[112:115]
    buffer_store_dwordx4 v[4:7], v2, s[52:55], s70 offen offset:0 sc1
    v_mul_f32 v104, s72, v104
    v_mul_f32 v105, s72, v105
    v_mul_f32 v106, s72, v106
    v_mul_f32 v107, s72, v107
    v_mfma_f32_16x16x32_bf16 v[116:119], v[28:31], v[164:167], v[116:119]
    v_mul_f32 v108, s72, v108
    v_mul_f32 v109, s72, v109
    v_mul_f32 v110, s72, v110
    v_mul_f32 v111, s72, v111
    v_cvt_pk_bf16_f32 v8, v104, v105
    v_mfma_f32_16x16x32_bf16 v[120:123], v[28:31], v[168:171], v[120:123]
    v_cvt_pk_bf16_f32 v9, v106, v107
    v_cvt_pk_bf16_f32 v10, v108, v109
    v_cvt_pk_bf16_f32 v11, v110, v111
    s_nop 0
    v_permlane16_swap_b32 v8, v10
    v_permlane16_swap_b32 v9, v11
    v_mfma_f32_16x16x32_bf16 v[124:127], v[28:31], v[172:175], v[124:127]
    buffer_store_dwordx4 v[8:11], v2, s[52:55], s70 offen offset:512 sc1
    s_add_u32 s70, s82, 196608
    v_mul_f32 v112, s72, v112
    v_mul_f32 v113, s72, v113
    v_mul_f32 v114, s72, v114
    v_mul_f32 v115, s72, v115
    v_mul_f32 v116, s72, v116
    v_mul_f32 v117, s72, v117
    v_mul_f32 v118, s72, v118
    v_mul_f32 v119, s72, v119
    v_cvt_pk_bf16_f32 v176, v112, v113
    v_cvt_pk_bf16_f32 v177, v114, v115
    v_cvt_pk_bf16_f32 v178, v116, v117
    v_cvt_pk_bf16_f32 v179, v118, v119
    s_nop 0
    v_permlane16_swap_b32 v176, v178
    v_permlane16_swap_b32 v177, v179
    buffer_store_dwordx4 v[176:179], v2, s[52:55], s70 offen offset:0 sc1
    v_mul_f32 v120, s72, v120
    v_mul_f32 v121, s72, v121
    v_mul_f32 v122, s72, v122
    v_mul_f32 v123, s72, v123
    v_mul_f32 v124, s72, v124
    v_mul_f32 v125, s72, v125
    v_mul_f32 v126, s72, v126
    v_mul_f32 v127, s72, v127
    v_cvt_pk_bf16_f32 v48, v120, v121
    v_cvt_pk_bf16_f32 v49, v122, v123
    v_cvt_pk_bf16_f32 v50, v124, v125
    v_cvt_pk_bf16_f32 v51, v126, v127
    s_nop 0
    v_permlane16_swap_b32 v48, v50
    v_permlane16_swap_b32 v49, v51
    buffer_store_dwordx4 v[48:51], v2, s[52:55], s70 offen offset:512 sc1
    v_mov_b32 v16, s60
    v_mov_b32 v17, s61
    s_lshl_b32 s70, s56, 2
    s_add_u32 s70, s70, 119712
    v_mov_b32 v18, s70
    v_and_b32 v19, 3, v1
    v_lshlrev_b32 v19, 2, v19
    v_add_u32 v19, 119712, v19
    ds_write_b32 v18, v16
    s_waitcnt vmcnt(0)
    s_mov_b64 exec, 15
    buffer_store_dwordx2 v[16:17], v200, s[52:55], 0 offen sc1
    s_mov_b64 exec, -1
    s_mov_b32 s76, 0
L_sync:
    ds_read_b32 v18, v19
    s_add_u32 s76, s76, 1
    s_waitcnt lgkmcnt(0)
    v_cmp_ne_u32 vcc, s60, v18
    s_cmp_gt_u32 s76, 0x100000
    s_cbranch_scc1 L_c_post
    s_cbranch_vccnz L_sync
L_c_post:
    v_and_b32 v10, 1, v1
    v_subrev_u32 v10, 1, v10
    v_and_b32 v10, 0x3f80, v10
    v_mov_b32 v11, 0
    v_mov_b32 v12, 0
    v_mov_b32 v13, 0
    v_lshlrev_b32 v7, 3, v1
    s_waitcnt vmcnt(0)
    s_mov_b32 s76, 0
L_poll_13:
    buffer_load_dwordx2 v[8:9], v207, s[52:55], 0 offen sc1
    s_waitcnt vmcnt(0)
    v_cmp_ne_u32 vcc, s60, v8
    v_cmp_ne_u32 s[80:81], s61, v9
    s_nop 0
    s_or_b64 vcc, vcc, s[80:81]
    s_cbranch_vccz L_polld_14
    s_add_u32 s76, s76, 1
    s_cmp_lt_u32 s76, 0x40000
    s_cbranch_scc0 L_polld_14
    s_sleep 1
    s_branch L_poll_13
L_polld_14:
    s_add_u32 s70, s0, 0
    s_add_u32 m0, s75, 83712
    s_nop 0
    buffer_load_dwordx4 v14, s[52:55], s70 offen sc1 lds
    s_add_u32 s70, s0, 32768
    s_add_u32 m0, s75, 87808
    s_nop 0
    buffer_load_dwordx4 v14, s[52:55], s70 offen sc1 lds
    s_add_u32 s70, s1, 0
    s_add_u32 m0, s75, 91904
    s_nop 0
    buffer_load_dwordx4 v14, s[52:55], s70 offen sc1 lds
    s_add_u32 s70, s0, 2621440
    s_add_u32 m0, s75, 63232
    s_nop 0
    buffer_load_dwordx4 v14, s[52:55], s70 offen sc1 lds
    s_add_u32 s70, s0, 2654208
    s_add_u32 m0, s75, 71424
    s_nop 0
    buffer_load_dwordx4 v14, s[52:55], s70 offen sc1 lds
    s_add_u32 s70, s1, 2621440
    s_add_u32 m0, s75, 79616
    s_nop 0
    buffer_load_dwordx4 v14, s[52:55], s70 offen sc1 lds
    s_add_u32 s70, s0, 5242880
    s_add_u32 m0, s75, 36864
    s_nop 0
    buffer_load_dwordx4 v14, s[52:55], s70 offen sc1 lds
    s_add_u32 s70, s0, 5275648
    s_add_u32 m0, s75, 45120
    s_nop 0
    buffer_load_dwordx4 v14, s[52:55], s70 offen sc1 lds
    s_add_u32 s70, s1, 5242880
    s_add_u32 m0, s75, 53376
    s_nop 0
    buffer_load_dwordx4 v14, s[52:55], s70 offen sc1 lds
    s_add_u32 s70, s0, 2617344
    s_add_u32 m0, s75, 59136
    s_nop 0
    buffer_load_dwordx4 v15, s[52:55], s70 offen sc1 lds
    s_add_u32 s70, s0, 2650112
    s_add_u32 m0, s75, 67328
    s_nop 0
    buffer_load_dwordx4 v15, s[52:55], s70 offen sc1 lds
    s_add_u32 s70, s1, 2617344
    s_add_u32 m0, s75, 75520
    s_nop 0
    buffer_load_dwordx4 v15, s[52:55], s70 offen sc1 lds
    s_add_u32 s70, s0, 5238784
    s_add_u32 m0, s75, 32768
    s_nop 0
    buffer_load_dwordx4 v15, s[52:55], s70 offen sc1 lds
    s_add_u32 s70, s0, 5271552
    s_add_u32 m0, s75, 41024
    s_nop 0
    buffer_load_dwordx4 v15, s[52:55], s70 offen sc1 lds
    s_add_u32 s70, s1, 5238784
    s_add_u32 m0, s75, 49280
    s_nop 0
    buffer_load_dwordx4 v15, s[52:55], s70 offen sc1 lds
    ds_write_b64 v7, v[10:11] offset:58048
    ds_write_b64 v7, v[10:11] offset:58560
    ds_write_b64 v7, v[12:13] offset:57536
    s_setprio 0
    s_waitcnt vmcnt(0) lgkmcnt(0)
    v_mov_b32 v170, 0
    v_mov_b32 v174, 0
    v_mov_b32 v175, 0
    v_mov_b32 v171, 0
    v_mov_b32 v177, 0
    v_mov_b32 v178, 0
    v_mov_b32 v179, 0
    s_branch L_join_b
L_join_a:
    s_setprio 1
L_join_b:
    s_barrier
    ds_read_b128 v[20:23], v202
    ds_read_b128 v[16:19], v201
    ds_read_b128 v[24:27], v197 offset:4096
    ds_read_b128 v[32:35], v198 offset:4096
    ds_read_b128 v[28:31], v197 offset:3584
    s_cmp_lt_u32 s56, 4
    s_cbranch_scc1 L_noq
    buffer_load_dwordx4 v[152:155], v174, s[20:23], s30 offen
    buffer_load_dwordx4 v[156:159], v174, s[20:23], s31 offen
    buffer_load_dwordx4 v[160:163], v175, s[20:23], s30 offen
L_noq:
    s_lshl_b32 s70, s69, 3
    s_add_u32 s70, s70, s56
    s_lshl_b32 s74, s68, 16
    s_lshl_b32 s72, s70, 9
    s_add_u32 s74, s74, s72
    s_add_u32 s74, s74, 14680064
    s_lshl_b32 s75, s68, 14
    s_lshl_b32 s73, s70, 8
    s_add_u32 s75, s75, s73
    s_add_u32 s75, s75, 16777216
    s_lshl_b32 s82, s70, 5
    s_add_u32 s82, s82, s68
    s_lshl_b32 s82, s82, 5
    s_add_u32 s82, s82, 18612224
    s_waitcnt lgkmcnt(4)
    v_and_b32 v60, v182, v20
    v_and_b32 v61, v182, v21
    v_and_b32 v62, v183, v22
    v_and_b32 v63, v183, v23
    v_and_b32 v20, v203, v20
    v_and_b32 v21, v203, v21
    v_and_b32 v22, v204, v22
    v_and_b32 v23, v204, v23
    s_waitcnt lgkmcnt(1)
    v_mfma_f32_32x32x16_bf16 v[64:79], v[24:27], v[16:19], v[224:239]
    v_mfma_f32_32x32x16_bf16 v[64:79], v[32:35], v[20:23], v[64:79]
    ds_read_b64_tr_b16 v[40:41], v190 offset:512
    ds_read_b64_tr_b16 v[42:43], v190 offset:640
    ds_read_b64_tr_b16 v[44:45], v190 offset:768
    ds_read_b64_tr_b16 v[46:47], v190 offset:896
    ds_read_b128 v[24:27], v197 offset:3072
    ds_read_b128 v[36:39], v198 offset:3072
    s_nop 5
    v_exp_f32 v64, v64
    v_exp_f32 v65, v65
    v_exp_f32 v66, v66
    v_exp_f32 v67, v67
    s_waitcnt lgkmcnt(6)
    v_mfma_f32_32x32x16_bf16 v[80:95], v[28:31], v[16:19], 0
    v_exp_f32 v68, v68
    v_exp_f32 v69, v69
    v_cvt_pk_bf16_f32 v96, v64, v65
    v_cvt_pk_bf16_f32 v97, v66, v67
    v_exp_f32 v70, v70
    v_exp_f32 v71, v71
    v_mfma_f32_32x32x16_bf16 v[80:95], v[32:35], v[60:63], v[80:95]
    v_exp_f32 v72, v72
    v_exp_f32 v73, v73
    v_cvt_pk_bf16_f32 v98, v68, v69
    v_cvt_pk_bf16_f32 v99, v70, v71
    v_exp_f32 v74, v74
    v_exp_f32 v75, v75
    s_barrier
    s_add_u32 m0, s24, 0
    s_nop 0
    buffer_load_dwordx4 v208, s[16:19], s7 offen lds
    s_add_u32 m0, s24, 8192
    s_nop 0
    buffer_load_dwordx4 v209, s[16:19], s7 offen lds
    v_exp_f32 v76, v76
    v_exp_f32 v77, v77
    v_cvt_pk_bf16_f32 v100, v72, v73
    v_cvt_pk_bf16_f32 v101, v74, v75
    v_exp_f32 v78, v78
    v_exp_f32 v79, v79
    s_waitcnt lgkmcnt(0)
    v_mfma_f32_32x32x16_bf16 v[112:127], v[40:43], v[96:99], 0
    ds_read_b64_tr_b16 v[48:49], v190 offset:0
    ds_read_b64_tr_b16 v[50:51], v190 offset:128
    ds_read_b64_tr_b16 v[52:53], v190 offset:256
    ds_read_b64_tr_b16 v[54:55], v190 offset:384
    ds_read_b128 v[28:31], v197 offset:2560
    v_exp_f32 v80, v80
    v_exp_f32 v81, v81
    v_cvt_pk_bf16_f32 v102, v76, v77
    v_cvt_pk_bf16_f32 v103, v78, v79
    v_exp_f32 v82, v82
    v_exp_f32 v83, v83
    v_mfma_f32_32x32x16_bf16 v[64:79], v[24:27], v[16:19], 0
    s_cmp_lg_u32 s67, 0
    s_cbranch_scc1 L_zp_15
L_zpr_16:
    s_add_u32 m0, s24, 16384
    s_nop 0
    buffer_load_dwordx4 v210, s[16:19], s7 offen lds
    v_exp_f32 v84, v84
    v_exp_f32 v85, v85
    v_cvt_pk_bf16_f32 v104, v80, v81
    v_cvt_pk_bf16_f32 v105, v82, v83
    v_exp_f32 v86, v86
    v_exp_f32 v87, v87
    v_mfma_f32_32x32x16_bf16 v[64:79], v[36:39], v[20:23], v[64:79]
    v_exp_f32 v88, v88
    v_exp_f32 v89, v89
    v_cvt_pk_bf16_f32 v106, v84, v85
    v_cvt_pk_bf16_f32 v107, v86, v87
    v_exp_f32 v90, v90
    v_exp_f32 v91, v91
    v_mfma_f32_32x32x16_bf16 v[112:127], v[44:47], v[100:103], v[112:127]
    s_add_u32 m0, s24, 24576
    s_nop 0
    buffer_load_dwordx4 v211, s[16:19], s7 offen lds
    v_exp_f32 v92, v92
    v_exp_f32 v93, v93
    v_cvt_pk_bf16_f32 v108, v88, v89
    v_cvt_pk_bf16_f32 v109, v90, v91
    v_exp_f32 v94, v94
    v_exp_f32 v95, v95
    s_waitcnt lgkmcnt(0)
    v_mfma_f32_32x32x16_bf16 v[112:127], v[48:51], v[104:107], v[112:127]
    ds_read_b64_tr_b16 v[40:41], v191 offset:512
    ds_read_b64_tr_b16 v[42:43], v191 offset:640
    ds_read_b64_tr_b16 v[44:45], v191 offset:768
    ds_read_b64_tr_b16 v[46:47], v191 offset:896
    ds_read_b128 v[24:27], v197 offset:2048
    ds_read_b128 v[32:35], v198 offset:2048
    v_exp_f32 v64, v64
    v_exp_f32 v65, v65
    v_cvt_pk_bf16_f32 v110, v92, v93
    v_cvt_pk_bf16_f32 v111, v94, v95
    v_exp_f32 v66, v66
    v_exp_f32 v67, v67
    v_mfma_f32_32x32x16_bf16 v[80:95], v[28:31], v[16:19], 0
    s_add_u32 m0, s24, 32768
    s_nop 0
    buffer_load_dwordx4 v212, s[16:19], s7 offen lds
    v_exp_f32 v68, v68
    v_exp_f32 v69, v69
    v_cvt_pk_bf16_f32 v96, v64, v65
    v_cvt_pk_bf16_f32 v97, v66, v67
    v_exp_f32 v70, v70
    v_exp_f32 v71, v71
    v_mfma_f32_32x32x16_bf16 v[80:95], v[36:39], v[60:63], v[80:95]
    v_exp_f32 v72, v72
    v_exp_f32 v73, v73
    v_cvt_pk_bf16_f32 v98, v68, v69
    v_cvt_pk_bf16_f32 v99, v70, v71
    v_exp_f32 v74, v74
    v_exp_f32 v75, v75
    v_mfma_f32_32x32x16_bf16 v[112:127], v[52:55], v[108:111], v[112:127]
    s_add_u32 m0, s24, 40960
    s_nop 0
    buffer_load_dwordx4 v208, s[16:19], s26 offen lds
    v_exp_f32 v76, v76
    v_exp_f32 v77, v77
    v_cvt_pk_bf16_f32 v100, v72, v73
    v_cvt_pk_bf16_f32 v101, v74, v75
    v_exp_f32 v78, v78
    v_exp_f32 v79, v79
    s_waitcnt lgkmcnt(0)
    v_mfma_f32_32x32x16_bf16 v[112:127], v[40:43], v[96:99], v[112:127]
    ds_read_b64_tr_b16 v[48:49], v191 offset:0
    ds_read_b64_tr_b16 v[50:51], v191 offset:128
    ds_read_b64_tr_b16 v[52:53], v191 offset:256
    ds_read_b64_tr_b16 v[54:55], v191 offset:384
    ds_read_b128 v[28:31], v197 offset:1536
    v_exp_f32 v80, v80
    v_exp_f32 v81, v81
    v_cvt_pk_bf16_f32 v102, v76, v77
    v_cvt_pk_bf16_f32 v103, v78, v79
    v_exp_f32 v82, v82
    v_exp_f32 v83, v83
    v_mfma_f32_32x32x16_bf16 v[64:79], v[24:27], v[16:19], 0
    s_add_u32 m0, s24, 49152
    s_nop 0
    buffer_load_dwordx4 v209, s[16:19], s26 offen lds
    v_exp_f32 v84, v84
    v_exp_f32 v85, v85
    v_cvt_pk_bf16_f32 v104, v80, v81
    v_cvt_pk_bf16_f32 v105, v82, v83
    v_exp_f32 v86, v86
    v_exp_f32 v87, v87
    v_mfma_f32_32x32x16_bf16 v[64:79], v[32:35], v[20:23], v[64:79]
    v_exp_f32 v88, v88
    v_exp_f32 v89, v89
    v_cvt_pk_bf16_f32 v106, v84, v85
    v_cvt_pk_bf16_f32 v107, v86, v87
    v_exp_f32 v90, v90
    v_exp_f32 v91, v91
    v_mfma_f32_32x32x16_bf16 v[112:127], v[44:47], v[100:103], v[112:127]
    s_add_u32 m0, s24, 57344
    s_nop 0
    buffer_load_dwordx4 v210, s[16:19], s26 offen lds
    v_exp_f32 v92, v92
    v_exp_f32 v93, v93
    v_cvt_pk_bf16_f32 v108, v88, v89
    v_cvt_pk_bf16_f32 v109, v90, v91
    v_exp_f32 v94, v94
    v_exp_f32 v95, v95
    s_waitcnt lgkmcnt(0)
    v_mfma_f32_32x32x16_bf16 v[112:127], v[48:51], v[104:107], v[112:127]
    ds_read_b64_tr_b16 v[40:41], v192 offset:512
    ds_read_b64_tr_b16 v[42:43], v192 offset:640
    ds_read_b64_tr_b16 v[44:45], v192 offset:768
    ds_read_b64_tr_b16 v[46:47], v192 offset:896
    ds_read_b128 v[24:27], v197 offset:1024
    ds_read_b128 v[36:39], v198 offset:1024
    v_exp_f32 v64, v64
    v_exp_f32 v65, v65
    v_cvt_pk_bf16_f32 v110, v92, v93
    v_cvt_pk_bf16_f32 v111, v94, v95
    v_exp_f32 v66, v66
    v_exp_f32 v67, v67
    v_mfma_f32_32x32x16_bf16 v[80:95], v[28:31], v[16:19], 0
    s_add_u32 m0, s24, 65536
    s_nop 0
    buffer_load_dwordx4 v211, s[16:19], s26 offen lds
    v_exp_f32 v68, v68
    v_exp_f32 v69, v69
    v_cvt_pk_bf16_f32 v96, v64, v65
    v_cvt_pk_bf16_f32 v97, v66, v67
    v_exp_f32 v70, v70
    v_exp_f32 v71, v71
    v_mfma_f32_32x32x16_bf16 v[80:95], v[32:35], v[60:63], v[80:95]
    v_exp_f32 v72, v72
    v_exp_f32 v73, v73
    v_cvt_pk_bf16_f32 v98, v68, v69
    v_cvt_pk_bf16_f32 v99, v70, v71
    v_exp_f32 v74, v74
    v_exp_f32 v75, v75
    v_mfma_f32_32x32x16_bf16 v[112:127], v[52:55], v[108:111], v[112:127]
    s_mov_b32 m0, s25
    s_nop 0
    buffer_load_dwordx4 v212, s[16:19], s26 offen lds
    v_exp_f32 v76, v76
    v_exp_f32 v77, v77
    v_cvt_pk_bf16_f32 v100, v72, v73
    v_cvt_pk_bf16_f32 v101, v74, v75
    v_exp_f32 v78, v78
    v_exp_f32 v79, v79
    s_setprio 0
    s_waitcnt lgkmcnt(0)
    v_mfma_f32_32x32x16_bf16 v[112:127], v[40:43], v[96:99], v[112:127]
    ds_read_b64_tr_b16 v[48:49], v192 offset:0
    ds_read_b64_tr_b16 v[50:51], v192 offset:128
    ds_read_b64_tr_b16 v[52:53], v192 offset:256
    ds_read_b64_tr_b16 v[54:55], v192 offset:384
    ds_read_b128 v[28:31], v197 offset:512
    v_exp_f32 v80, v80
    v_exp_f32 v81, v81
    v_cvt_pk_bf16_f32 v102, v76, v77
    v_cvt_pk_bf16_f32 v103, v78, v79
    v_exp_f32 v82, v82
    v_exp_f32 v83, v83
    v_mfma_f32_32x32x16_bf16 v[64:79], v[24:27], v[16:19], 0
    v_exp_f32 v84, v84
    v_exp_f32 v85, v85
    v_cvt_pk_bf16_f32 v104, v80, v81
    v_cvt_pk_bf16_f32 v105, v82, v83
    v_exp_f32 v86, v86
    v_exp_f32 v87, v87
    v_mfma_f32_32x32x16_bf16 v[64:79], v[36:39], v[20:23], v[64:79]
    v_exp_f32 v88, v88
    v_exp_f32 v89, v89
    v_cvt_pk_bf16_f32 v106, v84, v85
    v_cvt_pk_bf16_f32 v107, v86, v87
    v_exp_f32 v90, v90
    v_exp_f32 v91, v91
    v_mfma_f32_32x32x16_bf16 v[112:127], v[44:47], v[100:103], v[112:127]
    v_exp_f32 v92, v92
    v_exp_f32 v93, v93
    v_cvt_pk_bf16_f32 v108, v88, v89
    v_cvt_pk_bf16_f32 v109, v90, v91
    v_exp_f32 v94, v94
    v_exp_f32 v95, v95
    s_waitcnt lgkmcnt(0)
    v_mfma_f32_32x32x16_bf16 v[112:127], v[48:51], v[104:107], v[112:127]
    ds_read_b64_tr_b16 v[40:41], v193 offset:512
    ds_read_b64_tr_b16 v[42:43], v193 offset:640
    ds_read_b64_tr_b16 v[44:45], v193 offset:768
    ds_read_b64_tr_b16 v[46:47], v193 offset:896
    ds_read_b128 v[24:27], v197 offset:0
    ds_read_b128 v[32:35], v198 offset:0
    v_exp_f32 v64, v64
    v_exp_f32 v65, v65
    v_cvt_pk_bf16_f32 v110, v92, v93
    v_cvt_pk_bf16_f32 v111, v94, v95
    v_exp_f32 v66, v66
    v_exp_f32 v67, v67
    v_mfma_f32_32x32x16_bf16 v[80:95], v[28:31], v[16:19], 0
    v_exp_f32 v68, v68
    v_exp_f32 v69, v69
    v_cvt_pk_bf16_f32 v96, v64, v65
    v_cvt_pk_bf16_f32 v97, v66, v67
    v_exp_f32 v70, v70
    v_exp_f32 v71, v71
    v_mfma_f32_32x32x16_bf16 v[80:95], v[36:39], v[60:63], v[80:95]
    v_exp_f32 v72, v72
    v_exp_f32 v73, v73
    v_cvt_pk_bf16_f32 v98, v68, v69
    v_cvt_pk_bf16_f32 v99, v70, v71
    v_exp_f32 v74, v74
    v_exp_f32 v75, v75
    v_mfma_f32_32x32x16_bf16 v[112:127], v[52:55], v[108:111], v[112:127]
    v_exp_f32 v76, v76
    v_exp_f32 v77, v77
    v_cvt_pk_bf16_f32 v100, v72, v73
    v_cvt_pk_bf16_f32 v101, v74, v75
    v_exp_f32 v78, v78
    v_exp_f32 v79, v79
    s_waitcnt lgkmcnt(0)
    v_mfma_f32_32x32x16_bf16 v[112:127], v[40:43], v[96:99], v[112:127]
    ds_read_b64_tr_b16 v[48:49], v193 offset:0
    ds_read_b64_tr_b16 v[50:51], v193 offset:128
    ds_read_b64_tr_b16 v[52:53], v193 offset:256
    ds_read_b64_tr_b16 v[54:55], v193 offset:384
    v_exp_f32 v80, v80
    v_exp_f32 v81, v81
    v_cvt_pk_bf16_f32 v102, v76, v77
    v_cvt_pk_bf16_f32 v103, v78, v79
    v_exp_f32 v82, v82
    v_exp_f32 v83, v83
    v_mfma_f32_32x32x16_bf16 v[64:79], v[24:27], v[16:19], v[240:255]
    v_exp_f32 v84, v84
    v_exp_f32 v85, v85
    v_cvt_pk_bf16_f32 v104, v80, v81
    v_cvt_pk_bf16_f32 v105, v82, v83
    v_exp_f32 v86, v86
    v_exp_f32 v87, v87
    v_mfma_f32_32x32x16_bf16 v[64:79], v[32:35], v[20:23], v[64:79]
    v_exp_f32 v88, v88
    v_exp_f32 v89, v89
    v_cvt_pk_bf16_f32 v106, v84, v85
    v_cvt_pk_bf16_f32 v107, v86, v87
    v_exp_f32 v90, v90
    v_exp_f32 v91, v91
    v_mfma_f32_32x32x16_bf16 v[112:127], v[44:47], v[100:103], v[112:127]
    s_cmp_lt_u32 s56, 4
    s_cbranch_scc1 L_hq_17
    buffer_load_dwordx2 v[172:173], v170, s[52:55], 0 offen sc1
L_hq_17:
    v_exp_f32 v92, v92
    v_exp_f32 v93, v93
    v_cvt_pk_bf16_f32 v108, v88, v89
    v_cvt_pk_bf16_f32 v109, v90, v91
    v_exp_f32 v94, v94
    v_exp_f32 v95, v95
    s_waitcnt lgkmcnt(0)
    v_mfma_f32_32x32x16_bf16 v[112:127], v[48:51], v[104:107], v[112:127]
    ds_read_b64_tr_b16 v[40:41], v194 offset:512
    ds_read_b64_tr_b16 v[42:43], v194 offset:640
    ds_read_b64_tr_b16 v[44:45], v194 offset:768
    ds_read_b64_tr_b16 v[46:47], v194 offset:896
    v_exp_f32 v64, v64
    v_exp_f32 v65, v65
    v_cvt_pk_bf16_f32 v110, v92, v93
    v_cvt_pk_bf16_f32 v111, v94, v95
    v_exp_f32 v66, v66
    v_exp_f32 v67, v67
    v_mfma_f32_32x32x16_bf16 v[112:127], v[52:55], v[108:111], v[112:127]
    v_exp_f32 v68, v68
    v_exp_f32 v69, v69
    v_cvt_pk_bf16_f32 v96, v64, v65
    v_cvt_pk_bf16_f32 v97, v66, v67
    v_exp_f32 v70, v70
    v_exp_f32 v71, v71
    v_exp_f32 v72, v72
    v_exp_f32 v73, v73
    v_cvt_pk_bf16_f32 v98, v68, v69
    v_cvt_pk_bf16_f32 v99, v70, v71
    v_exp_f32 v74, v74
    v_exp_f32 v75, v75
    s_waitcnt lgkmcnt(0)
    v_mfma_f32_32x32x16_bf16 v[112:127], v[40:43], v[96:99], v[112:127]
    s_waitcnt vmcnt(1)
    s_cmp_ge_u32 s56, 4
    s_cbranch_scc1 L_wb_18
    s_waitcnt vmcnt(0)
L_wb_18:
    s_barrier
    v_exp_f32 v76, v76
    v_exp_f32 v77, v77
    v_cvt_pk_bf16_f32 v100, v72, v73
    v_cvt_pk_bf16_f32 v101, v74, v75
    v_exp_f32 v78, v78
    v_exp_f32 v79, v79
    v_cvt_pk_bf16_f32 v102, v76, v77
    v_cvt_pk_bf16_f32 v103, v78, v79
    s_nop 1
    v_mfma_f32_32x32x16_bf16 v[112:127], v[44:47], v[100:103], v[112:127]
L_a2_done:
    s_nop 11
    v_rcp_f32 v2, v124
    s_nop 0
    v_mov_b32 v3, v2
    v_pk_mul_f32 v[40:41], v[112:113], v[2:3]
    v_pk_mul_f32 v[42:43], v[114:115], v[2:3]
    v_pk_mul_f32 v[44:45], v[116:117], v[2:3]
    v_pk_mul_f32 v[46:47], v[118:119], v[2:3]
    v_pk_mul_f32 v[48:49], v[120:121], v[2:3]
    v_pk_mul_f32 v[50:51], v[122:123], v[2:3]
    v_cvt_pk_bf16_f32 v24, v40, v41
    v_cvt_pk_bf16_f32 v25, v42, v43
    v_cvt_pk_bf16_f32 v26, v44, v45
    v_cvt_pk_bf16_f32 v27, v46, v47
    v_cvt_pk_bf16_f32 v28, v48, v49
    v_cvt_pk_bf16_f32 v29, v50, v51
    buffer_store_dwordx4 v[24:27], v205, s[52:55], s74 offen sc1
    s_mov_b32 exec_hi, 0
    buffer_store_dwordx2 v[28:29], v206, s[52:55], s75 offen sc1
    s_mov_b32 exec_hi, -1
    v_cmp_nle_f32 vcc, 0x33800000, v124
    s_nop 0
    s_mov_b64 s[80:81], vcc
    v_cmp_nge_f32 vcc, 0x53800000, v124
    s_nop 0
    s_or_b64 s[80:81], s[80:81], vcc
    v_add_f32 v4, abs(v112), abs(v113)
    v_add_f32 v5, abs(v114), abs(v115)
    v_add_f32 v6, abs(v116), abs(v117)
    v_add_f32 v7, abs(v118), abs(v119)
    v_add_f32 v8, abs(v120), abs(v121)
    v_add_f32 v9, abs(v122), abs(v123)
    v_add_f32 v4, v4, v5
    v_add_f32 v6, v6, v7
    v_add_f32 v8, v8, v9
    v_add_f32 v4, v4, v6
    v_add_f32 v4, v4, v8
    v_cmp_nge_f32 vcc, 0x7f61b1e6, v4
    s_nop 0
    s_or_b64 vcc, s[80:81], vcc
    s_cbranch_vccnz L_a2_fb
L_a2_ok:
    v_lshrrev_b32 v2, 4, v1
    v_bfe_u32 v3, v1, 2, 2
    v_and_b32 v4, 3, v1
    v_lshlrev_b32 v4, 3, v4
    v_lshrrev_b32 v5, 1, v2
    v_mul_u32_u24 v5, 24, v5
    v_and_b32 v6, 1, v2
    v_lshl_add_u32 v5, v6, 2, v5
    v_add_u32 v5, v5, v3
    v_mul_u32_u24 v5, 160, v5
    v_add_u32 v13, v5, v4
    v_add_u32 v14, 125440, v13
    v_mul_u32_u24 v5, 40, v2
    v_add3_u32 v5, v5, v3, 16
    v_mul_u32_u24 v5, 160, v5
    v_add_u32 v7, v5, v4
    v_add_u32 v15, 87040, v7
    s_cmp_ge_u32 s56, 4
    s_cbranch_scc1 L_g2_h
    v_add_u32 v13, 87040, v13
    ds_read_b64_tr_b16 v[76:77], v13 offset:0
    ds_read_b64_tr_b16 v[78:79], v13 offset:1280
    ds_read_b64_tr_b16 v[80:81], v13 offset:32
    ds_read_b64_tr_b16 v[82:83], v13 offset:1312
    ds_read_b64_tr_b16 v[84:85], v13 offset:64
    ds_read_b64_tr_b16 v[86:87], v13 offset:1344
    ds_read_b64_tr_b16 v[88:89], v13 offset:96
    ds_read_b64_tr_b16 v[90:91], v13 offset:1376
    ds_read_b64_tr_b16 v[92:93], v13 offset:128
    ds_read_b64_tr_b16 v[94:95], v13 offset:1408
    ds_read_b64_tr_b16 v[96:97], v13 offset:6400
    ds_read_b64_tr_b16 v[98:99], v13 offset:7680
    ds_read_b64_tr_b16 v[100:101], v13 offset:6432
    ds_read_b64_tr_b16 v[102:103], v13 offset:7712
    ds_read_b64_tr_b16 v[104:105], v13 offset:6464
    ds_read_b64_tr_b16 v[106:107], v13 offset:7744
    ds_read_b64_tr_b16 v[108:109], v13 offset:6496
    ds_read_b64_tr_b16 v[110:111], v13 offset:7776
    ds_read_b64_tr_b16 v[112:113], v13 offset:6528
    ds_read_b64_tr_b16 v[114:115], v13 offset:7808
    s_waitcnt vmcnt(0)
    v_mov_b32 v4, s60
    v_mov_b32 v5, s61
    v_mov_b32 v6, s82
    s_mov_b64 exec, 1
    buffer_store_dwordx2 v[4:5], v6, s[52:55], 0 offen sc1
    s_mov_b64 exec, -1
    ds_read_b64_tr_b16 v[116:117], v13 offset:12800
    ds_read_b64_tr_b16 v[118:119], v13 offset:14080
    ds_read_b64_tr_b16 v[120:121], v13 offset:12832
    ds_read_b64_tr_b16 v[122:123], v13 offset:14112
    ds_read_b64_tr_b16 v[124:125], v13 offset:12864
    ds_read_b64_tr_b16 v[126:127], v13 offset:14144
    ds_read_b64_tr_b16 v[128:129], v13 offset:12896
    ds_read_b64_tr_b16 v[130:131], v13 offset:14176
    ds_read_b64_tr_b16 v[132:133], v13 offset:12928
    ds_read_b64_tr_b16 v[134:135], v13 offset:14208
    ds_read_b64_tr_b16 v[136:137], v13 offset:19200
    ds_read_b64_tr_b16 v[138:139], v13 offset:20480
    ds_read_b64_tr_b16 v[140:141], v13 offset:19232
    ds_read_b64_tr_b16 v[142:143], v13 offset:20512
    ds_read_b64_tr_b16 v[144:145], v13 offset:19264
    ds_read_b64_tr_b16 v[146:147], v13 offset:20544
    ds_read_b64_tr_b16 v[148:149], v13 offset:19296
    ds_read_b64_tr_b16 v[150:151], v13 offset:20576
    ds_read_b64_tr_b16 v[152:153], v13 offset:19328
    ds_read_b64_tr_b16 v[154:155], v13 offset:20608
    s_barrier
    ds_read_b64_tr_b16 v[156:157], v15 offset:0
    ds_read_b64_tr_b16 v[158:159], v15 offset:640
    ds_read_b64_tr_b16 v[160:161], v15 offset:32
    ds_read_b64_tr_b16 v[162:163], v15 offset:672
    ds_read_b64_tr_b16 v[164:165], v15 offset:64
    ds_read_b64_tr_b16 v[166:167], v15 offset:704
    ds_read_b64_tr_b16 v[168:169], v15 offset:96
    ds_read_b64_tr_b16 v[170:171], v15 offset:736
    ds_read_b64_tr_b16 v[172:173], v15 offset:128
    ds_read_b64_tr_b16 v[174:175], v15 offset:768
    ds_read_b64_tr_b16 v[176:177], v13 offset:25600
    ds_read_b64_tr_b16 v[178:179], v13 offset:26880
    ds_read_b64_tr_b16 v[180:181], v13 offset:25632
    ds_read_b64_tr_b16 v[182:183], v13 offset:26912
    ds_read_b64_tr_b16 v[184:185], v13 offset:25664
    ds_read_b64_tr_b16 v[186:187], v13 offset:26944
    ds_read_b64_tr_b16 v[188:189], v13 offset:25696
    ds_read_b64_tr_b16 v[190:191], v13 offset:26976
    ds_read_b64_tr_b16 v[192:193], v13 offset:25728
    ds_read_b64_tr_b16 v[194:195], v13 offset:27008
    ds_read_b64_tr_b16 v[196:197], v13 offset:32000
    ds_read_b64_tr_b16 v[198:199], v13 offset:33280
    ds_read_b64_tr_b16 v[200:201], v13 offset:32032
    ds_read_b64_tr_b16 v[202:203], v13 offset:33312
    ds_read_b64_tr_b16 v[204:205], v13 offset:32064
    ds_read_b64_tr_b16 v[206:207], v13 offset:33344
    ds_read_b64_tr_b16 v[208:209], v13 offset:32096
    ds_read_b64_tr_b16 v[210:211], v13 offset:33376
    ds_read_b64_tr_b16 v[212:213], v13 offset:32128
    ds_read_b64_tr_b16 v[214:215], v13 offset:33408
    ds_read_b64_tr_b16 v[216:217], v14 offset:0
    ds_read_b64_tr_b16 v[218:219], v14 offset:1280
    ds_read_b64_tr_b16 v[220:221], v14 offset:32
    ds_read_b64_tr_b16 v[222:223], v14 offset:1312
    ds_read_b64_tr_b16 v[224:225], v14 offset:64
    ds_read_b64_tr_b16 v[226:227], v14 offset:1344
    ds_read_b64_tr_b16 v[228:229], v14 offset:96
    ds_read_b64_tr_b16 v[230:231], v14 offset:1376
    ds_read_b64_tr_b16 v[232:233], v14 offset:128
    ds_read_b64_tr_b16 v[234:235], v14 offset:1408
    ds_read_b64_tr_b16 v[236:237], v14 offset:6400
    ds_read_b64_tr_b16 v[238:239], v14 offset:7680
    ds_read_b64_tr_b16 v[240:241], v14 offset:6432
    ds_read_b64_tr_b16 v[242:243], v14 offset:7712
    ds_read_b64_tr_b16 v[244:245], v14 offset:6464
    ds_read_b64_tr_b16 v[246:247], v14 offset:7744
    ds_read_b64_tr_b16 v[248:249], v14 offset:6496
    ds_read_b64_tr_b16 v[250:251], v14 offset:7776
    ds_read_b64_tr_b16 v[252:253], v14 offset:6528
    ds_read_b64_tr_b16 v[254:255], v14 offset:7808
    v_and_b32 v2, 15, v1
    v_lshrrev_b32 v3, 4, v1
    v_lshlrev_b32 v3, 15, v3
    v_lshl_add_u32 v9, v2, 4, v3
    v_lshl_add_u32 v12, v2, 3, v3
    s_lshl2_add_u32 s70, s62, s59
    s_lshl_b32 s83, s70, 8
    s_lshl_b32 s74, s70, 7
    s_and_b32 s70, s70, -2
    s_add_u32 s70, s70, 0
    s_lshl_b32 s70, s70, 9
    s_add_u32 s70, s70, 18612224
    v_lshl_add_u32 v8, v2, 5, s70
    s_mov_b32 s76, 0
L_poll_19:
    buffer_load_dwordx2 v[10:11], v8, s[52:55], 0 offen sc1
    s_waitcnt vmcnt(0)
    v_cmp_ne_u32 vcc, s60, v10
    v_cmp_ne_u32 s[80:81], s61, v11
    s_nop 0
    s_or_b64 vcc, vcc, s[80:81]
    s_cbranch_vccz L_polld_20
    s_add_u32 s76, s76, 1
    s_cmp_lt_u32 s76, 0x40000
    s_cbranch_scc0 L_polld_20
    s_sleep 1
    s_branch L_poll_19
L_polld_20:
    s_add_u32 s70, s83, 14680064
    buffer_load_dwordx4 v[36:39], v9, s[52:55], s70 offen sc1
    s_add_u32 s70, s83, 14811136
    buffer_load_dwordx4 v[40:43], v9, s[52:55], s70 offen sc1
    s_add_u32 s70, s83, 14942208
    buffer_load_dwordx4 v[44:47], v9, s[52:55], s70 offen sc1
    s_add_u32 s70, s83, 15073280
    buffer_load_dwordx4 v[48:51], v9, s[52:55], s70 offen sc1
    s_add_u32 s70, s74, 16777216
    buffer_load_dwordx2 v[52:53], v12, s[52:55], s70 offen sc1
    s_add_u32 s70, s74, 16793600
    buffer_load_dwordx2 v[54:55], v12, s[52:55], s70 offen sc1
    s_add_u32 s70, s83, 15204352
    buffer_load_dwordx4 v[56:59], v9, s[52:55], s70 offen sc1
    s_add_u32 s70, s83, 15335424
    buffer_load_dwordx4 v[60:63], v9, s[52:55], s70 offen sc1
    s_add_u32 s70, s83, 15466496
    buffer_load_dwordx4 v[64:67], v9, s[52:55], s70 offen sc1
    s_add_u32 s70, s83, 15597568
    buffer_load_dwordx4 v[68:71], v9, s[52:55], s70 offen sc1
    s_add_u32 s70, s74, 16908288
    buffer_load_dwordx2 v[72:73], v12, s[52:55], s70 offen sc1
    s_add_u32 s70, s74, 16924672
    buffer_load_dwordx2 v[74:75], v12, s[52:55], s70 offen sc1
    s_mul_i32 s70, s59, 5120
    s_add_u32 s70, s70, 32768
    v_lshl_add_u32 v2, v1, 4, s70
    s_lshl_b32 s70, s59, 2
    s_add_u32 s70, s70, 86800
    v_mov_b32 v3, s70
    v_mov_b32 v4, s60
    s_waitcnt lgkmcnt(0)
    s_waitcnt vmcnt(11)
    v_mfma_f32_16x16x32_bf16 v[16:19], v[76:79], v[36:39], 0
    v_mfma_f32_16x16x32_bf16 v[20:23], v[80:83], v[36:39], 0
    v_mfma_f32_16x16x32_bf16 v[24:27], v[84:87], v[36:39], 0
    v_mfma_f32_16x16x32_bf16 v[28:31], v[88:91], v[36:39], 0
    v_mfma_f32_16x16x32_bf16 v[32:35], v[92:95], v[36:39], 0
    s_waitcnt vmcnt(10)
    v_mfma_f32_16x16x32_bf16 v[16:19], v[96:99], v[40:43], v[16:19]
    ds_read_b64_tr_b16 v[76:77], v15 offset:25600
    ds_read_b64_tr_b16 v[78:79], v15 offset:26240
    v_mfma_f32_16x16x32_bf16 v[20:23], v[100:103], v[40:43], v[20:23]
    ds_read_b64_tr_b16 v[80:81], v15 offset:25632
    ds_read_b64_tr_b16 v[82:83], v15 offset:26272
    v_mfma_f32_16x16x32_bf16 v[24:27], v[104:107], v[40:43], v[24:27]
    ds_read_b64_tr_b16 v[84:85], v15 offset:25664
    ds_read_b64_tr_b16 v[86:87], v15 offset:26304
    v_mfma_f32_16x16x32_bf16 v[28:31], v[108:111], v[40:43], v[28:31]
    ds_read_b64_tr_b16 v[88:89], v15 offset:25696
    ds_read_b64_tr_b16 v[90:91], v15 offset:26336
    v_mfma_f32_16x16x32_bf16 v[32:35], v[112:115], v[40:43], v[32:35]
    ds_read_b64_tr_b16 v[92:93], v15 offset:25728
    ds_read_b64_tr_b16 v[94:95], v15 offset:26368
    s_waitcnt vmcnt(9)
    v_mfma_f32_16x16x32_bf16 v[16:19], v[116:119], v[44:47], v[16:19]
    v_mfma_f32_16x16x32_bf16 v[20:23], v[120:123], v[44:47], v[20:23]
    v_mfma_f32_16x16x32_bf16 v[24:27], v[124:127], v[44:47], v[24:27]
    v_mfma_f32_16x16x32_bf16 v[28:31], v[128:131], v[44:47], v[28:31]
    v_mfma_f32_16x16x32_bf16 v[32:35], v[132:135], v[44:47], v[32:35]
    s_waitcnt vmcnt(8)
    v_mfma_f32_16x16x32_bf16 v[16:19], v[136:139], v[48:51], v[16:19]
    v_mfma_f32_16x16x32_bf16 v[20:23], v[140:143], v[48:51], v[20:23]
    v_mfma_f32_16x16x32_bf16 v[24:27], v[144:147], v[48:51], v[24:27]
    v_mfma_f32_16x16x32_bf16 v[28:31], v[148:151], v[48:51], v[28:31]
    v_mfma_f32_16x16x32_bf16 v[32:35], v[152:155], v[48:51], v[32:35]
    s_waitcnt vmcnt(6)
    v_mfma_f32_16x16x32_bf16 v[16:19], v[156:159], v[52:55], v[16:19]
    v_mfma_f32_16x16x32_bf16 v[20:23], v[160:163], v[52:55], v[20:23]
    v_mfma_f32_16x16x32_bf16 v[24:27], v[164:167], v[52:55], v[24:27]
    v_mfma_f32_16x16x32_bf16 v[28:31], v[168:171], v[52:55], v[28:31]
    v_mfma_f32_16x16x32_bf16 v[32:35], v[172:175], v[52:55], v[32:35]
    s_waitcnt vmcnt(5)
    v_mfma_f32_16x16x32_bf16 v[16:19], v[176:179], v[56:59], v[16:19]
    v_mfma_f32_16x16x32_bf16 v[20:23], v[180:183], v[56:59], v[20:23]
    v_mfma_f32_16x16x32_bf16 v[24:27], v[184:187], v[56:59], v[24:27]
    v_mfma_f32_16x16x32_bf16 v[28:31], v[188:191], v[56:59], v[28:31]
    v_mfma_f32_16x16x32_bf16 v[32:35], v[192:195], v[56:59], v[32:35]
    s_waitcnt vmcnt(4)
    v_mfma_f32_16x16x32_bf16 v[16:19], v[196:199], v[60:63], v[16:19]
    v_mfma_f32_16x16x32_bf16 v[20:23], v[200:203], v[60:63], v[20:23]
    v_mfma_f32_16x16x32_bf16 v[24:27], v[204:207], v[60:63], v[24:27]
    v_mfma_f32_16x16x32_bf16 v[28:31], v[208:211], v[60:63], v[28:31]
    v_mfma_f32_16x16x32_bf16 v[32:35], v[212:215], v[60:63], v[32:35]
    s_waitcnt vmcnt(3)
    v_mfma_f32_16x16x32_bf16 v[16:19], v[216:219], v[64:67], v[16:19]
    v_mfma_f32_16x16x32_bf16 v[20:23], v[220:223], v[64:67], v[20:23]
    v_mfma_f32_16x16x32_bf16 v[24:27], v[224:227], v[64:67], v[24:27]
    v_mfma_f32_16x16x32_bf16 v[28:31], v[228:231], v[64:67], v[28:31]
    v_mfma_f32_16x16x32_bf16 v[32:35], v[232:235], v[64:67], v[32:35]
    s_waitcnt vmcnt(2)
    v_mfma_f32_16x16x32_bf16 v[16:19], v[236:239], v[68:71], v[16:19]
    v_mfma_f32_16x16x32_bf16 v[20:23], v[240:243], v[68:71], v[20:23]
    v_mfma_f32_16x16x32_bf16 v[24:27], v[244:247], v[68:71], v[24:27]
    v_mfma_f32_16x16x32_bf16 v[28:31], v[248:251], v[68:71], v[28:31]
    v_mfma_f32_16x16x32_bf16 v[32:35], v[252:255], v[68:71], v[32:35]
    s_waitcnt vmcnt(0)
    s_waitcnt lgkmcnt(0)
    v_mfma_f32_16x16x32_bf16 v[16:19], v[76:79], v[72:75], v[16:19]
    v_mfma_f32_16x16x32_bf16 v[20:23], v[80:83], v[72:75], v[20:23]
    v_mfma_f32_16x16x32_bf16 v[24:27], v[84:87], v[72:75], v[24:27]
    v_mfma_f32_16x16x32_bf16 v[28:31], v[88:91], v[72:75], v[28:31]
    v_mfma_f32_16x16x32_bf16 v[32:35], v[92:95], v[72:75], v[32:35]
    s_nop 3
    ds_write_b128 v2, v[16:19] offset:0
    ds_write_b128 v2, v[20:23] offset:1024
    ds_write_b128 v2, v[24:27] offset:2048
    ds_write_b128 v2, v[28:31] offset:3072
    ds_write_b128 v2, v[32:35] offset:4096
    ds_write_b32 v3, v4
    s_waitcnt lgkmcnt(0)
    s_branch L_fin
L_g2_h:
    s_setprio 2
    v_lshrrev_b32 v2, 3, v1
    v_and_b32 v3, 7, v1
    v_lshlrev_b32 v2, 12, v2
    v_lshl_add_u32 v2, v3, 4, v2
    s_mul_i32 s70, s63, 327680
    s_lshl_b32 s71, s62, 7
    s_add_u32 s70, s70, s71
    s_add_u32 s70, s70, 11534336
    s_add_u32 s71, s59, 0
    s_min_u32 s71, s71, 9
    s_and_b32 s72, s71, 7
    s_lshl_b32 s72, s72, 4
    v_xor_b32 v3, s72, v2
    s_lshl_b32 s72, s71, 15
    s_add_u32 s72, s72, s70
    v_add_u32 v177, s72, v3
    s_lshl_b32 s72, s71, 10
    s_cmp_gt_u32 s71, 6
    s_cselect_b32 s71, 50944, 0
    s_add_u32 s72, s72, s71
    s_add_u32 s0, s72, 25600
    s_add_u32 s71, s59, 4
    s_min_u32 s71, s71, 9
    s_and_b32 s72, s71, 7
    s_lshl_b32 s72, s72, 4
    v_xor_b32 v3, s72, v2
    s_lshl_b32 s72, s71, 15
    s_add_u32 s72, s72, s70
    v_add_u32 v178, s72, v3
    s_lshl_b32 s72, s71, 10
    s_cmp_gt_u32 s71, 6
    s_cselect_b32 s71, 50944, 0
    s_add_u32 s72, s72, s71
    s_add_u32 s1, s72, 25600
    s_add_u32 s71, s59, 8
    s_min_u32 s71, s71, 9
    s_and_b32 s72, s71, 7
    s_lshl_b32 s72, s72, 4
    v_xor_b32 v3, s72, v2
    s_lshl_b32 s72, s71, 15
    s_add_u32 s72, s72, s70
    v_add_u32 v179, s72, v3
    s_lshl_b32 s72, s71, 10
    s_cmp_gt_u32 s71, 6
    s_cselect_b32 s71, 50944, 0
    s_add_u32 s72, s72, s71
    s_add_u32 s3, s72, 25600
    v_and_b32 v2, 15, v1
    v_lshrrev_b32 v3, 4, v1
    v_lshlrev_b32 v3, 15, v3
    v_lshl_add_u32 v9, v2, 4, v3
    v_lshl_add_u32 v12, v2, 3, v3
    s_lshl2_add_u32 s70, s62, s59
    s_lshl_b32 s83, s70, 8
    s_lshl_b32 s74, s70, 7
    s_and_b32 s70, s70, -2
    s_add_u32 s70, s70, 1
    s_lshl_b32 s70, s70, 9
    s_add_u32 s70, s70, 18612224
    v_lshl_add_u32 v8, v2, 5, s70
    s_waitcnt vmcnt(0)
    v_mov_b32 v32, s60
    v_mov_b32 v33, s61
    v_mov_b32 v34, s82
    s_mov_b64 exec, 1
    buffer_store_dwordx2 v[32:33], v34, s[52:55], 0 offen sc1
    s_mov_b64 exec, -1
    v_cmp_ne_u32 vcc, s60, v172
    v_cmp_ne_u32 s[80:81], s61, v173
    s_nop 0
    s_or_b64 vcc, vcc, s[80:81]
    s_cbranch_vccnz L_cp_21
L_cpr_22:
    s_mov_b32 m0, s0
    s_nop 0
    buffer_load_dwordx4 v177, s[52:55], 0 offen sc1 lds
    s_mov_b32 m0, s1
    s_nop 0
    buffer_load_dwordx4 v178, s[52:55], 0 offen sc1 lds
    s_mov_b32 m0, s3
    s_nop 0
    buffer_load_dwordx4 v179, s[52:55], 0 offen sc1 lds
    s_barrier
    ds_read_b64_tr_b16 v[76:77], v14 offset:12800
    v_subrev_u32 v2, 256, v0
    v_mul_u32_u24 v3, 205, v2
    ds_read_b64_tr_b16 v[78:79], v14 offset:14080
    v_lshrrev_b32 v3, 11, v3
    v_mul_u32_u24 v5, 2400, v3
    ds_read_b64_tr_b16 v[80:81], v14 offset:12832
    v_lshl_add_u32 v164, v2, 4, v5
    v_mul_u32_u24 v4, 10, v3
    ds_read_b64_tr_b16 v[82:83], v14 offset:14112
    v_sub_u32 v4, v2, v4
    v_lshlrev_b32 v5, 3, v4
    ds_read_b64_tr_b16 v[84:85], v14 offset:12864
    v_xor_b32 v5, v5, v3
    v_and_b32 v5, 63, v5
    ds_read_b64_tr_b16 v[86:87], v14 offset:14144
    v_lshlrev_b32 v5, 1, v5
    v_lshl_add_u32 v5, v4, 10, v5
    ds_read_b64_tr_b16 v[88:89], v14 offset:12896
    v_cmp_lt_u32 vcc, 6, v4
    v_add_u32 v6, 25600, v5
    ds_read_b64_tr_b16 v[90:91], v14 offset:14176
    v_add_u32 v5, 76544, v5
    v_cndmask_b32 v167, v6, v5, vcc
    ds_read_b64_tr_b16 v[92:93], v14 offset:12928
    s_and_b32 s70, s59, 1
    s_mul_i32 s70, s70, 320
    ds_read_b64_tr_b16 v[94:95], v14 offset:14208
    s_add_u32 s70, s70, 256
    v_add_u32 v2, s70, v1
    ds_read_b64_tr_b16 v[96:97], v14 offset:19200
    v_mul_u32_u24 v3, 205, v2
    v_lshrrev_b32 v3, 11, v3
    ds_read_b64_tr_b16 v[98:99], v14 offset:20480
    v_mul_u32_u24 v5, 2400, v3
    v_lshl_add_u32 v166, v2, 4, v5
    ds_read_b64_tr_b16 v[100:101], v14 offset:19232
    v_mul_u32_u24 v4, 10, v3
    v_sub_u32 v4, v2, v4
    ds_read_b64_tr_b16 v[102:103], v14 offset:20512
    v_lshlrev_b32 v5, 3, v4
    v_xor_b32 v5, v5, v3
    ds_read_b64_tr_b16 v[104:105], v14 offset:19264
    v_and_b32 v5, 63, v5
    v_lshlrev_b32 v5, 1, v5
    ds_read_b64_tr_b16 v[106:107], v14 offset:20544
    v_lshl_add_u32 v5, v4, 10, v5
    v_cmp_lt_u32 vcc, 6, v4
    ds_read_b64_tr_b16 v[108:109], v14 offset:19296
    v_add_u32 v6, 25600, v5
    v_add_u32 v5, 76544, v5
    ds_read_b64_tr_b16 v[110:111], v14 offset:20576
    v_cndmask_b32 v169, v6, v5, vcc
    v_add_u32 v165, 81920, v164
    ds_read_b64_tr_b16 v[112:113], v14 offset:19328
    v_xor_b32 v168, 64, v167
    s_mul_i32 s70, s59, 5120
    ds_read_b64_tr_b16 v[114:115], v14 offset:20608
    s_add_u32 s70, s70, 32768
    v_lshl_add_u32 v148, v1, 4, s70
    ds_read_b64_tr_b16 v[116:117], v14 offset:25600
    s_lshl_b32 s70, s59, 2
    s_add_u32 s70, s70, 86800
    ds_read_b64_tr_b16 v[118:119], v14 offset:26880
    v_mov_b32 v149, s70
    s_mul_i32 s70, s59, 2816
    ds_read_b64_tr_b16 v[120:121], v14 offset:25632
    s_add_u32 s70, s70, 53248
    v_and_b32 v2, 15, v1
    ds_read_b64_tr_b16 v[122:123], v14 offset:26912
    v_lshrrev_b32 v3, 4, v1
    v_mul_u32_u24 v4, 176, v2
    ds_read_b64_tr_b16 v[124:125], v14 offset:25664
    v_lshl_add_u32 v4, v3, 3, v4
    v_add_u32 v252, s70, v4
    ds_read_b64_tr_b16 v[126:127], v14 offset:26944
    s_and_b32 s71, s63, 3
    s_lshl_b32 s71, s71, 1
    ds_read_b64_tr_b16 v[128:129], v14 offset:25696
    v_subrev_u32 v2, s71, v2
    v_cmp_gt_u32 vcc, 10, v2
    ds_read_b64_tr_b16 v[130:131], v14 offset:26976
    v_min_u32 v2, 9, v2
    v_lshlrev_b32 v2, 4, v2
    ds_read_b64_tr_b16 v[132:133], v14 offset:25728
    v_mul_u32_u24 v4, 176, v3
    v_add3_u32 v253, v4, v2, s70
    ds_read_b64_tr_b16 v[134:135], v14 offset:27008
    v_mul_u32_u24 v4, 2560, v3
    v_add_u32 v4, v4, v2
    ds_read_b64_tr_b16 v[136:137], v14 offset:32000
    v_bfrev_b32 v5, 1
    v_cndmask_b32 v254, v5, v4, vcc
    ds_read_b64_tr_b16 v[138:139], v14 offset:33280
    s_lshl2_add_u32 s73, s62, s59
    s_mul_i32 s73, s73, 40960
    ds_read_b64_tr_b16 v[140:141], v14 offset:32032
    s_add_u32 s73, s73, s7
    v_mov_b32 v150, s60
    ds_read_b64_tr_b16 v[142:143], v14 offset:33312
    v_subrev_u32 v151, 16, v149
    s_mul_i32 s72, s62, 163840
    ds_read_b64_tr_b16 v[144:145], v14 offset:32064
    s_add_u32 s72, s72, s7
    s_add_u32 s72, s72, 1280
    ds_read_b64_tr_b16 v[146:147], v14 offset:33344
    v_and_b32 v4, 3, v1
    v_lshlrev_b32 v4, 2, v4
    ds_read_b64_tr_b16 v[184:185], v14 offset:32096
    v_add_u32 v4, 86784, v4
    s_cmp_ge_u32 s59, 2
    ds_read_b64_tr_b16 v[186:187], v14 offset:33376
    s_cselect_b32 s70, -1, 0
    v_or_b32 v166, s70, v166
    ds_read_b64_tr_b16 v[188:189], v14 offset:32128
    v_mov_b32 v36, 0
    v_mov_b32 v37, 0
    ds_read_b64_tr_b16 v[190:191], v14 offset:33408
    v_mov_b32 v38, 0
    v_mov_b32 v39, 0
    v_mov_b32 v40, 0
    v_mov_b32 v41, 0
    v_mov_b32 v42, 0
    v_mov_b32 v43, 0
    v_mov_b32 v44, 0
    v_mov_b32 v45, 0
    v_mov_b32 v46, 0
    v_mov_b32 v47, 0
    v_mov_b32 v48, 0
    v_mov_b32 v49, 0
    v_mov_b32 v50, 0
    v_mov_b32 v51, 0
    v_mov_b32 v52, 0
    v_mov_b32 v53, 0
    v_mov_b32 v54, 0
    v_mov_b32 v55, 0
    v_mov_b32 v56, 0
    v_mov_b32 v57, 0
    v_mov_b32 v58, 0
    v_mov_b32 v59, 0
    s_waitcnt vmcnt(0)
    ds_write_b32 v151, v150
    buffer_load_dwordx2 v[10:11], v8, s[52:55], 0 offen sc1
    s_mov_b32 s76, 0
L_sp_23:
    ds_read_b32 v5, v4
    s_add_u32 s76, s76, 1
    s_waitcnt lgkmcnt(0)
    v_cmp_ne_u32 vcc, s60, v5
    s_cmp_gt_u32 s76, 0x400000
    s_cbranch_scc1 L_spd_24
    s_cbranch_vccnz L_sp_23
L_spd_24:
    ds_read_u16_d16_hi v36, v167 offset:0
    ds_read_u16_d16_hi v37, v167 offset:128
    ds_read_u16_d16_hi v38, v167 offset:256
    ds_read_u16_d16_hi v39, v167 offset:384
    ds_read_u16_d16_hi v40, v167 offset:512
    ds_read_u16_d16_hi v41, v167 offset:640
    ds_read_u16_d16_hi v42, v167 offset:768
    ds_read_u16_d16_hi v43, v167 offset:896
    ds_read_u16_d16_hi v44, v168 offset:0
    ds_read_u16_d16_hi v45, v168 offset:128
    ds_read_u16_d16_hi v46, v168 offset:256
    ds_read_u16_d16_hi v47, v168 offset:384
    ds_read_u16_d16_hi v48, v168 offset:512
    ds_read_u16_d16_hi v49, v168 offset:640
    ds_read_u16_d16_hi v50, v168 offset:768
    ds_read_u16_d16_hi v51, v168 offset:896
    ds_read_u16_d16_hi v52, v169 offset:0
    ds_read_u16_d16_hi v53, v169 offset:128
    ds_read_u16_d16_hi v54, v169 offset:256
    ds_read_u16_d16_hi v55, v169 offset:384
    ds_read_u16_d16_hi v56, v169 offset:512
    ds_read_u16_d16_hi v57, v169 offset:640
    ds_read_u16_d16_hi v58, v169 offset:768
    ds_read_u16_d16_hi v59, v169 offset:896
    v_lshlrev_b32 v174, 16, v152
    v_and_b32 v175, 0xffff0000, v152
    v_lshlrev_b32 v176, 16, v153
    v_and_b32 v177, 0xffff0000, v153
    v_lshlrev_b32 v178, 16, v154
    v_and_b32 v179, 0xffff0000, v154
    v_lshlrev_b32 v180, 16, v155
    v_and_b32 v181, 0xffff0000, v155
    s_waitcnt lgkmcnt(15)
    v_mul_f32 v174, v174, v36
    v_mul_f32 v175, v175, v37
    v_mul_f32 v176, v176, v38
    v_mul_f32 v177, v177, v39
    v_mul_f32 v178, v178, v40
    v_mul_f32 v179, v179, v41
    v_mul_f32 v180, v180, v42
    v_mul_f32 v181, v181, v43
    v_cvt_pk_bf16_f32 v152, v174, v175
    v_cvt_pk_bf16_f32 v153, v176, v177
    v_cvt_pk_bf16_f32 v154, v178, v179
    v_cvt_pk_bf16_f32 v155, v180, v181
    v_lshlrev_b32 v174, 16, v156
    v_and_b32 v175, 0xffff0000, v156
    v_lshlrev_b32 v176, 16, v157
    v_and_b32 v177, 0xffff0000, v157
    v_lshlrev_b32 v178, 16, v158
    v_and_b32 v179, 0xffff0000, v158
    v_lshlrev_b32 v180, 16, v159
    v_and_b32 v181, 0xffff0000, v159
    s_waitcnt lgkmcnt(8)
    v_mul_f32 v174, v174, v44
    v_mul_f32 v175, v175, v45
    v_mul_f32 v176, v176, v46
    v_mul_f32 v177, v177, v47
    v_mul_f32 v178, v178, v48
    v_mul_f32 v179, v179, v49
    v_mul_f32 v180, v180, v50
    v_mul_f32 v181, v181, v51
    v_cvt_pk_bf16_f32 v156, v174, v175
    v_cvt_pk_bf16_f32 v157, v176, v177
    v_cvt_pk_bf16_f32 v158, v178, v179
    v_cvt_pk_bf16_f32 v159, v180, v181
    v_lshlrev_b32 v174, 16, v160
    v_and_b32 v175, 0xffff0000, v160
    v_lshlrev_b32 v176, 16, v161
    v_and_b32 v177, 0xffff0000, v161
    v_lshlrev_b32 v178, 16, v162
    v_and_b32 v179, 0xffff0000, v162
    v_lshlrev_b32 v180, 16, v163
    v_and_b32 v181, 0xffff0000, v163
    s_waitcnt lgkmcnt(0)
    v_mul_f32 v174, v174, v52
    v_mul_f32 v175, v175, v53
    v_mul_f32 v176, v176, v54
    v_mul_f32 v177, v177, v55
    v_mul_f32 v178, v178, v56
    v_mul_f32 v179, v179, v57
    v_mul_f32 v180, v180, v58
    v_mul_f32 v181, v181, v59
    v_cvt_pk_bf16_f32 v160, v174, v175
    v_cvt_pk_bf16_f32 v161, v176, v177
    v_cvt_pk_bf16_f32 v162, v178, v179
    v_cvt_pk_bf16_f32 v163, v180, v181
    s_waitcnt vmcnt(0)
    v_cmp_ne_u32 vcc, s60, v10
    v_cmp_ne_u32 s[80:81], s61, v11
    s_nop 0
    s_or_b64 vcc, vcc, s[80:81]
    s_cbranch_vccnz L_cp_25
L_cpr_26:
    s_add_u32 s70, s83, 15728640
    buffer_load_dwordx4 v[36:39], v9, s[52:55], s70 offen sc1
    s_add_u32 s70, s83, 15859712
    buffer_load_dwordx4 v[40:43], v9, s[52:55], s70 offen sc1
    s_add_u32 s70, s83, 15990784
    buffer_load_dwordx4 v[44:47], v9, s[52:55], s70 offen sc1
    s_add_u32 s70, s83, 16121856
    buffer_load_dwordx4 v[48:51], v9, s[52:55], s70 offen sc1
    s_add_u32 s70, s74, 17039360
    buffer_load_dwordx2 v[52:53], v12, s[52:55], s70 offen sc1
    s_add_u32 s70, s74, 17055744
    buffer_load_dwordx2 v[54:55], v12, s[52:55], s70 offen sc1
    s_add_u32 s70, s83, 16252928
    buffer_load_dwordx4 v[56:59], v9, s[52:55], s70 offen sc1
    s_add_u32 s70, s83, 16384000
    buffer_load_dwordx4 v[60:63], v9, s[52:55], s70 offen sc1
    s_add_u32 s70, s83, 16515072
    buffer_load_dwordx4 v[64:67], v9, s[52:55], s70 offen sc1
    s_add_u32 s70, s83, 16646144
    buffer_load_dwordx4 v[68:71], v9, s[52:55], s70 offen sc1
    s_add_u32 s70, s74, 17170432
    buffer_load_dwordx2 v[72:73], v12, s[52:55], s70 offen sc1
    s_add_u32 s70, s74, 17186816
    buffer_load_dwordx2 v[74:75], v12, s[52:55], s70 offen sc1
    s_setprio 0
    ds_read_b64_tr_b16 v[192:193], v15 offset:51200
    ds_read_b64_tr_b16 v[194:195], v15 offset:51840
    ds_read_b64_tr_b16 v[196:197], v15 offset:51232
    ds_read_b64_tr_b16 v[198:199], v15 offset:51872
    ds_read_b64_tr_b16 v[200:201], v15 offset:51264
    ds_read_b64_tr_b16 v[202:203], v15 offset:51904
    ds_read_b64_tr_b16 v[204:205], v15 offset:51296
    ds_read_b64_tr_b16 v[206:207], v15 offset:51936
    ds_read_b64_tr_b16 v[208:209], v15 offset:51328
    ds_read_b64_tr_b16 v[210:211], v15 offset:51968
    ds_read_b64_tr_b16 v[212:213], v13 offset:0
    ds_read_b64_tr_b16 v[214:215], v13 offset:1280
    ds_read_b64_tr_b16 v[216:217], v13 offset:32
    ds_read_b64_tr_b16 v[218:219], v13 offset:1312
    ds_read_b64_tr_b16 v[220:221], v13 offset:64
    ds_read_b64_tr_b16 v[222:223], v13 offset:1344
    ds_read_b64_tr_b16 v[224:225], v13 offset:96
    ds_read_b64_tr_b16 v[226:227], v13 offset:1376
    ds_read_b64_tr_b16 v[228:229], v13 offset:128
    ds_read_b64_tr_b16 v[230:231], v13 offset:1408
    ds_read_b64_tr_b16 v[232:233], v13 offset:6400
    ds_read_b64_tr_b16 v[234:235], v13 offset:7680
    ds_read_b64_tr_b16 v[236:237], v13 offset:6432
    ds_read_b64_tr_b16 v[238:239], v13 offset:7712
    ds_read_b64_tr_b16 v[240:241], v13 offset:6464
    ds_read_b64_tr_b16 v[242:243], v13 offset:7744
    ds_read_b64_tr_b16 v[244:245], v13 offset:6496
    ds_read_b64_tr_b16 v[246:247], v13 offset:7776
    ds_read_b64_tr_b16 v[248:249], v13 offset:6528
    ds_read_b64_tr_b16 v[250:251], v13 offset:7808
    s_waitcnt lgkmcnt(0)
    s_waitcnt vmcnt(11)
    v_mfma_f32_16x16x32_bf16 v[16:19], v[76:79], v[36:39], 0
    v_mfma_f32_16x16x32_bf16 v[20:23], v[80:83], v[36:39], 0
    v_mfma_f32_16x16x32_bf16 v[24:27], v[84:87], v[36:39], 0
    v_mfma_f32_16x16x32_bf16 v[28:31], v[88:91], v[36:39], 0
    v_mfma_f32_16x16x32_bf16 v[32:35], v[92:95], v[36:39], 0
    s_waitcnt vmcnt(10)
    v_mfma_f32_16x16x32_bf16 v[16:19], v[96:99], v[40:43], v[16:19]
    ds_read_b64_tr_b16 v[76:77], v13 offset:12800
    ds_read_b64_tr_b16 v[78:79], v13 offset:14080
    v_mfma_f32_16x16x32_bf16 v[20:23], v[100:103], v[40:43], v[20:23]
    ds_read_b64_tr_b16 v[80:81], v13 offset:12832
    ds_read_b64_tr_b16 v[82:83], v13 offset:14112
    v_mfma_f32_16x16x32_bf16 v[24:27], v[104:107], v[40:43], v[24:27]
    ds_read_b64_tr_b16 v[84:85], v13 offset:12864
    ds_read_b64_tr_b16 v[86:87], v13 offset:14144
    v_mfma_f32_16x16x32_bf16 v[28:31], v[108:111], v[40:43], v[28:31]
    ds_read_b64_tr_b16 v[88:89], v13 offset:12896
    ds_read_b64_tr_b16 v[90:91], v13 offset:14176
    v_mfma_f32_16x16x32_bf16 v[32:35], v[112:115], v[40:43], v[32:35]
    ds_read_b64_tr_b16 v[92:93], v13 offset:12928
    ds_read_b64_tr_b16 v[94:95], v13 offset:14208
    buffer_store_dwordx4 v[152:155], v164, s[44:47], s72 offen sc1
    buffer_store_dwordx4 v[156:159], v165, s[44:47], s72 offen sc1
    buffer_store_dwordx4 v[160:163], v166, s[44:47], s72 offen sc1
    s_waitcnt vmcnt(12)
    v_mfma_f32_16x16x32_bf16 v[16:19], v[116:119], v[44:47], v[16:19]
    ds_read_b64_tr_b16 v[96:97], v13 offset:19200
    ds_read_b64_tr_b16 v[98:99], v13 offset:20480
    v_mfma_f32_16x16x32_bf16 v[20:23], v[120:123], v[44:47], v[20:23]
    ds_read_b64_tr_b16 v[100:101], v13 offset:19232
    ds_read_b64_tr_b16 v[102:103], v13 offset:20512
    v_mfma_f32_16x16x32_bf16 v[24:27], v[124:127], v[44:47], v[24:27]
    ds_read_b64_tr_b16 v[104:105], v13 offset:19264
    ds_read_b64_tr_b16 v[106:107], v13 offset:20544
    v_mfma_f32_16x16x32_bf16 v[28:31], v[128:131], v[44:47], v[28:31]
    ds_read_b64_tr_b16 v[108:109], v13 offset:19296
    ds_read_b64_tr_b16 v[110:111], v13 offset:20576
    v_mfma_f32_16x16x32_bf16 v[32:35], v[132:135], v[44:47], v[32:35]
    ds_read_b64_tr_b16 v[112:113], v13 offset:19328
    ds_read_b64_tr_b16 v[114:115], v13 offset:20608
    s_waitcnt vmcnt(11)
    v_mfma_f32_16x16x32_bf16 v[16:19], v[136:139], v[48:51], v[16:19]
    ds_read_b64_tr_b16 v[116:117], v7 offset:0
    ds_read_b64_tr_b16 v[118:119], v7 offset:640
    v_mfma_f32_16x16x32_bf16 v[20:23], v[140:143], v[48:51], v[20:23]
    ds_read_b64_tr_b16 v[120:121], v7 offset:32
    ds_read_b64_tr_b16 v[122:123], v7 offset:672
    v_mfma_f32_16x16x32_bf16 v[24:27], v[144:147], v[48:51], v[24:27]
    ds_read_b64_tr_b16 v[124:125], v7 offset:64
    ds_read_b64_tr_b16 v[126:127], v7 offset:704
    v_mfma_f32_16x16x32_bf16 v[28:31], v[184:187], v[48:51], v[28:31]
    ds_read_b64_tr_b16 v[128:129], v7 offset:96
    ds_read_b64_tr_b16 v[130:131], v7 offset:736
    v_mfma_f32_16x16x32_bf16 v[32:35], v[188:191], v[48:51], v[32:35]
    ds_read_b64_tr_b16 v[132:133], v7 offset:128
    ds_read_b64_tr_b16 v[134:135], v7 offset:768
    s_waitcnt vmcnt(9)
    v_mfma_f32_16x16x32_bf16 v[16:19], v[192:195], v[52:55], v[16:19]
    v_mfma_f32_16x16x32_bf16 v[20:23], v[196:199], v[52:55], v[20:23]
    v_mfma_f32_16x16x32_bf16 v[24:27], v[200:203], v[52:55], v[24:27]
    v_mfma_f32_16x16x32_bf16 v[28:31], v[204:207], v[52:55], v[28:31]
    v_mfma_f32_16x16x32_bf16 v[32:35], v[208:211], v[52:55], v[32:35]
    s_waitcnt vmcnt(8)
    v_mfma_f32_16x16x32_bf16 v[16:19], v[212:215], v[56:59], v[16:19]
    v_mfma_f32_16x16x32_bf16 v[20:23], v[216:219], v[56:59], v[20:23]
    v_mfma_f32_16x16x32_bf16 v[24:27], v[220:223], v[56:59], v[24:27]
    v_mfma_f32_16x16x32_bf16 v[28:31], v[224:227], v[56:59], v[28:31]
    v_mfma_f32_16x16x32_bf16 v[32:35], v[228:231], v[56:59], v[32:35]
    s_waitcnt vmcnt(7)
    v_mfma_f32_16x16x32_bf16 v[16:19], v[232:235], v[60:63], v[16:19]
    v_mfma_f32_16x16x32_bf16 v[20:23], v[236:239], v[60:63], v[20:23]
    v_mfma_f32_16x16x32_bf16 v[24:27], v[240:243], v[60:63], v[24:27]
    v_mfma_f32_16x16x32_bf16 v[28:31], v[244:247], v[60:63], v[28:31]
    v_mfma_f32_16x16x32_bf16 v[32:35], v[248:251], v[60:63], v[32:35]
    s_waitcnt vmcnt(6)
    s_waitcnt lgkmcnt(15)
    v_mfma_f32_16x16x32_bf16 v[16:19], v[76:79], v[64:67], v[16:19]
    v_mfma_f32_16x16x32_bf16 v[20:23], v[80:83], v[64:67], v[20:23]
    v_mfma_f32_16x16x32_bf16 v[24:27], v[84:87], v[64:67], v[24:27]
    v_mfma_f32_16x16x32_bf16 v[28:31], v[88:91], v[64:67], v[28:31]
    v_mfma_f32_16x16x32_bf16 v[32:35], v[92:95], v[64:67], v[32:35]
    s_mov_b32 s76, 0
L_sp_27:
    ds_read_b32 v5, v149
    s_add_u32 s76, s76, 1
    s_waitcnt lgkmcnt(0)
    v_cmp_ne_u32 vcc, s60, v5
    s_cmp_gt_u32 s76, 0x400000
    s_cbranch_scc1 L_spd_28
    s_cbranch_vccnz L_sp_27
L_spd_28:
    ds_read_b128 v[36:39], v148 offset:0
    ds_read_b128 v[40:43], v148 offset:1024
    ds_read_b128 v[44:47], v148 offset:2048
    ds_read_b128 v[48:51], v148 offset:3072
    ds_read_b128 v[52:55], v148 offset:4096
    s_waitcnt vmcnt(5)
    v_mfma_f32_16x16x32_bf16 v[16:19], v[96:99], v[68:71], v[16:19]
    v_mfma_f32_16x16x32_bf16 v[20:23], v[100:103], v[68:71], v[20:23]
    v_mfma_f32_16x16x32_bf16 v[24:27], v[104:107], v[68:71], v[24:27]
    v_mfma_f32_16x16x32_bf16 v[28:31], v[108:111], v[68:71], v[28:31]
    v_mfma_f32_16x16x32_bf16 v[32:35], v[112:115], v[68:71], v[32:35]
    s_waitcnt vmcnt(3)
    v_mfma_f32_16x16x32_bf16 v[16:19], v[116:119], v[72:75], v[16:19]
    v_mfma_f32_16x16x32_bf16 v[20:23], v[120:123], v[72:75], v[20:23]
    v_mfma_f32_16x16x32_bf16 v[24:27], v[124:127], v[72:75], v[24:27]
    v_mfma_f32_16x16x32_bf16 v[28:31], v[128:131], v[72:75], v[28:31]
    v_mfma_f32_16x16x32_bf16 v[32:35], v[132:135], v[72:75], v[32:35]
    s_waitcnt lgkmcnt(0)
    s_nop 2
    v_add_f32 v16, v16, v36
    v_add_f32 v17, v17, v37
    v_add_f32 v18, v18, v38
    v_add_f32 v19, v19, v39
    v_cvt_pk_bf16_f32 v2, v16, v17
    v_cvt_pk_bf16_f32 v3, v18, v19
    ds_write_b64 v252, v[2:3] offset:0
    v_add_f32 v20, v20, v40
    v_add_f32 v21, v21, v41
    v_add_f32 v22, v22, v42
    v_add_f32 v23, v23, v43
    v_cvt_pk_bf16_f32 v4, v20, v21
    v_cvt_pk_bf16_f32 v5, v22, v23
    ds_write_b64 v252, v[4:5] offset:32
    v_add_f32 v24, v24, v44
    v_add_f32 v25, v25, v45
    v_add_f32 v26, v26, v46
    v_add_f32 v27, v27, v47
    v_cvt_pk_bf16_f32 v6, v24, v25
    v_cvt_pk_bf16_f32 v7, v26, v27
    ds_write_b64 v252, v[6:7] offset:64
    v_add_f32 v28, v28, v48
    v_add_f32 v29, v29, v49
    v_add_f32 v30, v30, v50
    v_add_f32 v31, v31, v51
    v_cvt_pk_bf16_f32 v8, v28, v29
    v_cvt_pk_bf16_f32 v9, v30, v31
    ds_write_b64 v252, v[8:9] offset:96
    v_add_f32 v32, v32, v52
    v_add_f32 v33, v33, v53
    v_add_f32 v34, v34, v54
    v_add_f32 v35, v35, v55
    v_cvt_pk_bf16_f32 v10, v32, v33
    v_cvt_pk_bf16_f32 v11, v34, v35
    ds_write_b64 v252, v[10:11] offset:128
    ds_read_b128 v[56:59], v253 offset:0
    ds_read_b128 v[60:63], v253 offset:704
    ds_read_b128 v[64:67], v253 offset:1408
    ds_read_b128 v[68:71], v253 offset:2112
    s_waitcnt lgkmcnt(3)
    buffer_store_dwordx4 v[56:59], v254, s[44:47], s73 offen
    s_add_u32 s73, s73, 10240
    s_waitcnt lgkmcnt(2)
    buffer_store_dwordx4 v[60:63], v254, s[44:47], s73 offen
    s_add_u32 s73, s73, 10240
    s_waitcnt lgkmcnt(1)
    buffer_store_dwordx4 v[64:67], v254, s[44:47], s73 offen
    s_add_u32 s73, s73, 10240
    s_waitcnt lgkmcnt(0)
    buffer_store_dwordx4 v[68:71], v254, s[44:47], s73 offen
    s_add_u32 s73, s73, 10240
L_fin:
L_exit:
    s_endpgm
L_non_1:
    s_add_u32 s76, s76, 1
    s_cmp_lt_u32 s76, 0x40000
    s_cbranch_scc0 L_nond_3
    buffer_load_dwordx2 v[22:23], v24, s[48:51], 0 offen sc1
    s_waitcnt vmcnt(0)
    s_branch L_nonr_2
L_cp_4:
    s_mov_b32 s76, 0
L_poll_29:
    buffer_load_dwordx2 v[14:15], v12, s[52:55], 0 offen sc1
    s_waitcnt vmcnt(0)
    v_cmp_ne_u32 vcc, s60, v14
    v_cmp_ne_u32 s[80:81], s61, v15
    s_nop 0
    s_or_b64 vcc, vcc, s[80:81]
    s_cbranch_vccz L_polld_30
    s_add_u32 s76, s76, 1
    s_cmp_lt_u32 s76, 0x40000
    s_cbranch_scc0 L_polld_30
    s_sleep 1
    s_branch L_poll_29
L_polld_30:
    s_branch L_cpr_5
L_h_idle:
    s_mov_b32 s18, 819200
    s_mov_b32 s19, 0x20000
    s_mov_b32 s22, 2621440
    s_mov_b32 s23, 0x20000
    s_mov_b32 s38, 2621440
    s_mov_b32 s39, 0x20000
    s_mov_b32 s42, 1280
    s_mov_b32 s43, 0x20000
    s_mov_b32 s46, 5242880
    s_mov_b32 s47, 0x20000
    s_mov_b32 s50, 256
    s_mov_b32 s51, 0x20000
    s_mov_b32 s54, 25165824
    s_mov_b32 s55, 0x20000
    s_mul_i32 s70, s58, 3
    s_lshl_b32 s71, s58, 1
    s_add_u32 s71, s71, 16
    s_cmp_lt_u32 s58, 16
    s_cselect_b32 s70, s70, s71
    s_cselect_b32 s71, 3, 2
    s_cmp_lt_u32 s70, 80
    s_cselect_b32 s71, s71, 0
    s_cselect_b32 s70, s70, 0
    s_cmp_lt_u32 s59, s71
    s_cselect_b32 s67, 1, 0
    s_cselect_b32 s71, s59, 0
    s_add_u32 s70, s70, s71
    s_mul_i32 s66, s57, 80
    s_add_u32 s66, s66, s70
    s_bfe_u32 s71, s70, 0x20002
    s_cmp_lt_u32 s70, 64
    s_cselect_b32 s72, 4, 31
    s_cselect_b32 s71, 0, s71
    s_lshr_b32 s70, s70, s72
    s_add_u32 s70, s70, s71
    s_lshl_b32 s71, s57, 2
    s_add_u32 s70, s70, s71
    s_lshl_b32 s70, s70, 5
    v_and_b32 v12, 31, v1
    v_add_u32 v12, s70, v12
    v_mul_u32_u24 v12, 8, v12
    v_add_u32 v12, 18087936, v12
    v_and_b32 v2, 15, v1
    v_lshrrev_b32 v3, 4, v1
    v_add_u32 v4, 1, v2
    v_lshrrev_b32 v4, 1, v4
    v_lshl_add_u32 v4, v3, 2, v4
    v_lshlrev_b32 v4, 2, v4
    v_and_b32 v5, 1, v2
    v_cmp_eq_u32 vcc, 0, v5
    v_mov_b32 v5, 4160
    s_nop 0
    v_cndmask_b32 v5, 0, v5, vcc
    s_mul_i32 s71, s59, s67
    s_mul_i32 s70, s71, 8320
    s_add_u32 s70, s70, 119808
    v_add3_u32 v26, v4, v5, s70
    v_add_u32 v27, 1024, v26
    v_add_u32 v28, 2048, v26
    v_add_u32 v29, 3072, v26
    v_lshlrev_b32 v13, 4, v1
    v_add_u32 v25, s70, v13
    v_lshlrev_b32 v4, 5, v2
    v_lshl_add_u32 v4, v3, 3, v4
    s_lshl_b32 s70, s59, 12
    s_add_u32 s70, s70, 98304
    v_add_u32 v31, s70, v4
    v_add_u32 v180, s70, v13
    v_sub_u32 v4, 15, v2
    v_lshlrev_b32 v4, 5, v4
    v_lshl_add_u32 v4, v3, 4, v4
    s_mul_i32 s71, s71, 4608
    s_add_u32 s71, s71, 144768
    v_add_u32 v30, s71, v4
    v_lshl_add_u32 v2, v1, 3, s71
    v_mov_b32 v4, 0
    v_mov_b32 v5, 0
    v_mov_b32 v6, 0
    v_mov_b32 v7, 0
    ds_write_b64 v2, v[4:5] offset:4096
    s_mov_b64 exec, 3
    ds_write_b128 v25, v[4:7]
    ds_write_b128 v25, v[4:7] offset:4160
    s_mov_b64 exec, -1
    s_waitcnt vmcnt(0) lgkmcnt(0)
    v_mov_b32 v199, 0
    v_mov_b32 v189, 0
    s_cmp_ge_u32 s59, 4
    s_cbranch_scc1 L_as_31
    s_add_u32 s70, s79, s59
    s_sub_u32 s71, s70, 10
    s_min_u32 s70, s70, s71
    s_mul_i32 s70, s70, 245760
    s_add_u32 s70, s70, 1792
    v_mul_u32_u24 v2, 3840, v1
    s_waitcnt vmcnt(0)
    buffer_load_dword v62, v2, s[12:15], s70 offen
    buffer_load_dword v62, v2, s[12:15], s70 offen offset:128
L_as_31:
    s_barrier
    v_mov_b32 v24, 0
    buffer_load_dwordx2 v[22:23], v24, s[48:51], 0 offen sc1
    s_barrier
    s_waitcnt vmcnt(0)
    s_mov_b32 s76, 0
L_nonr_33:
    v_readfirstlane_b32 s60, v22
    v_readfirstlane_b32 s61, v23
    s_cmp_eq_u32 s60, 0
    s_cbranch_scc1 L_non_32
L_nond_34:
    s_cmp_eq_u32 s67, 0
    s_cbranch_scc1 L_h_nob2
    buffer_load_dwordx2 v[14:15], v12, s[52:55], 0 offen sc1
    s_mul_i32 s73, s59, 8320
    s_mul_i32 s73, s73, s67
    s_lshl_b32 s70, s66, 12
    s_add_u32 m0, s73, 119840
    s_lshl_b32 s74, s66, 1
    v_mov_b32 v4, s74
    buffer_load_dwordx4 v13, s[36:39], s70 offen offset:0  lds
    buffer_load_dwordx4 v13, s[36:39], s70 offen offset:1024  lds
    buffer_load_dwordx4 v13, s[36:39], s70 offen offset:2048  lds
    buffer_load_dwordx4 v13, s[36:39], s70 offen offset:3072  lds
    buffer_load_ushort v21, v4, s[40:43], 0 offen
    s_waitcnt vmcnt(5)
    v_cmp_ne_u32 vcc, s60, v14
    v_cmp_ne_u32 s[80:81], s61, v15
    s_nop 0
    s_or_b64 vcc, vcc, s[80:81]
    s_cbranch_vccnz L_cp_35
L_cpr_36:
    s_mul_i32 s72, s59, 4608
    s_lshl_b32 s70, s66, 12
    s_add_u32 s71, s70, 8388608
    s_add_u32 m0, s72, 144768
    s_nop 0
    buffer_load_dwordx4 v13, s[52:55], s71 offen offset:0 sc1 lds
    buffer_load_dwordx4 v13, s[52:55], s71 offen offset:1024 sc1 lds
    buffer_load_dwordx4 v13, s[52:55], s71 offen offset:2048 sc1 lds
    buffer_load_dwordx4 v13, s[52:55], s71 offen offset:3072 sc1 lds
    v_and_b32 v2, 31, v1
    v_lshrrev_b32 v3, 5, v1
    v_lshlrev_b32 v3, 2, v3
    v_sub_u32 v2, v2, v3
    v_mov_b32 v3, 0xf149f2ca
    v_cmp_gt_i32 vcc, 0, v2
    v_cmp_gt_i32 s[80:81], 1, v2
    s_nop 0
    v_cndmask_b32 v224, 0, v3, vcc
    v_cndmask_b32 v225, 0, v3, s[80:81]
    v_cmp_gt_i32 vcc, 2, v2
    v_cmp_gt_i32 s[80:81], 3, v2
    v_xor_b32 v240, v3, v224
    v_xor_b32 v241, v3, v225
    v_cndmask_b32 v226, 0, v3, vcc
    v_cndmask_b32 v227, 0, v3, s[80:81]
    v_cmp_gt_i32 vcc, 8, v2
    v_cmp_gt_i32 s[80:81], 9, v2
    v_xor_b32 v242, v3, v226
    v_xor_b32 v243, v3, v227
    v_cndmask_b32 v228, 0, v3, vcc
    v_cndmask_b32 v229, 0, v3, s[80:81]
    v_cmp_gt_i32 vcc, 10, v2
    v_cmp_gt_i32 s[80:81], 11, v2
    v_xor_b32 v244, v3, v228
    v_xor_b32 v245, v3, v229
    v_cndmask_b32 v230, 0, v3, vcc
    v_cndmask_b32 v231, 0, v3, s[80:81]
    v_cmp_gt_i32 vcc, 16, v2
    v_cmp_gt_i32 s[80:81], 17, v2
    v_xor_b32 v246, v3, v230
    v_xor_b32 v247, v3, v231
    v_cndmask_b32 v232, 0, v3, vcc
    v_cndmask_b32 v233, 0, v3, s[80:81]
    v_cmp_gt_i32 vcc, 18, v2
    v_cmp_gt_i32 s[80:81], 19, v2
    v_xor_b32 v248, v3, v232
    v_xor_b32 v249, v3, v233
    v_cndmask_b32 v234, 0, v3, vcc
    v_cndmask_b32 v235, 0, v3, s[80:81]
    v_cmp_gt_i32 vcc, 24, v2
    v_cmp_gt_i32 s[80:81], 25, v2
    v_xor_b32 v250, v3, v234
    v_xor_b32 v251, v3, v235
    v_cndmask_b32 v236, 0, v3, vcc
    v_cndmask_b32 v237, 0, v3, s[80:81]
    v_cmp_gt_i32 vcc, 26, v2
    v_cmp_gt_i32 s[80:81], 27, v2
    v_xor_b32 v252, v3, v236
    v_xor_b32 v253, v3, v237
    v_cndmask_b32 v238, 0, v3, vcc
    v_cndmask_b32 v239, 0, v3, s[80:81]
    v_xor_b32 v254, v3, v238
    v_xor_b32 v255, v3, v239
    v_add_u32 v2, 110592, v13
    ds_write_b128 v2, v[224:227] offset:0
    ds_write_b128 v2, v[228:231] offset:1024
    ds_write_b128 v2, v[232:235] offset:2048
    ds_write_b128 v2, v[236:239] offset:3072
    ds_write_b128 v2, v[240:243] offset:4096
    ds_write_b128 v2, v[244:247] offset:5120
    ds_write_b128 v2, v[248:251] offset:6144
    ds_write_b128 v2, v[252:255] offset:7168
    s_branch L_h_post
L_h_nob2a:
    v_add_u32 v2, 0, v1
    v_mul_u32_u24 v3, 205, v2
    v_lshrrev_b32 v3, 11, v3
    v_mul_u32_u24 v3, 1120, v3
    v_lshl_add_u32 v32, v2, 4, v3
    v_add_u32 v2, 64, v1
    v_mul_u32_u24 v3, 205, v2
    v_lshrrev_b32 v3, 11, v3
    v_mul_u32_u24 v3, 1120, v3
    v_lshl_add_u32 v33, v2, 4, v3
    v_add_u32 v2, 128, v1
    v_mul_u32_u24 v3, 205, v2
    v_lshrrev_b32 v3, 11, v3
    v_mul_u32_u24 v3, 1120, v3
    v_lshl_add_u32 v34, v2, 4, v3
    v_add_u32 v2, 192, v1
    v_mul_u32_u24 v3, 205, v2
    v_lshrrev_b32 v3, 11, v3
    v_mul_u32_u24 v3, 1120, v3
    v_lshl_add_u32 v35, v2, 4, v3
    v_add_u32 v2, 256, v1
    v_mul_u32_u24 v3, 205, v2
    v_lshrrev_b32 v3, 11, v3
    v_mul_u32_u24 v3, 1120, v3
    v_lshl_add_u32 v36, v2, 4, v3
    s_waitcnt vmcnt(8)
    s_barrier
    s_waitcnt vmcnt(0)
    s_barrier
    s_branch L_h_nob2b
L_h_nob2:
    v_add_u32 v2, 0, v1
    v_mul_u32_u24 v3, 205, v2
    v_lshrrev_b32 v3, 11, v3
    v_mul_u32_u24 v3, 1120, v3
    v_lshl_add_u32 v32, v2, 4, v3
    v_add_u32 v2, 64, v1
    v_mul_u32_u24 v3, 205, v2
    v_lshrrev_b32 v3, 11, v3
    v_mul_u32_u24 v3, 1120, v3
    v_lshl_add_u32 v33, v2, 4, v3
    v_add_u32 v2, 128, v1
    v_mul_u32_u24 v3, 205, v2
    v_lshrrev_b32 v3, 11, v3
    v_mul_u32_u24 v3, 1120, v3
    v_lshl_add_u32 v34, v2, 4, v3
    v_add_u32 v2, 192, v1
    v_mul_u32_u24 v3, 205, v2
    v_lshrrev_b32 v3, 11, v3
    v_mul_u32_u24 v3, 1120, v3
    v_lshl_add_u32 v35, v2, 4, v3
    v_add_u32 v2, 256, v1
    v_mul_u32_u24 v3, 205, v2
    v_lshrrev_b32 v3, 11, v3
    v_mul_u32_u24 v3, 1120, v3
    v_lshl_add_u32 v36, v2, 4, v3
L_h_nob2b:
    s_waitcnt lgkmcnt(0)
    s_lshl_b32 s83, s66, 1
    v_mov_b32 v12, s83
    buffer_load_ushort v21, v12, s[40:43], 0 offen offset:0
    buffer_load_ushort v22, v12, s[40:43], 0 offen offset:2
    buffer_load_ushort v23, v12, s[40:43], 0 offen offset:4
    s_cmp_lg_u32 s56, 7
    s_cbranch_scc1 L_h_nob2c
    s_add_u32 s83, s7, 655360
    s_mov_b32 m0, 5120
    s_nop 0
    buffer_load_dwordx4 v32, s[16:19], s83 offen  lds
    s_mov_b32 m0, 6144
    s_nop 0
    buffer_load_dwordx4 v33, s[16:19], s83 offen  lds
    s_mov_b32 m0, 7168
    s_nop 0
    buffer_load_dwordx4 v34, s[16:19], s83 offen  lds
    s_mov_b32 m0, 8192
    s_nop 0
    buffer_load_dwordx4 v35, s[16:19], s83 offen  lds
    s_mov_b32 m0, 9216
    s_nop 0
    buffer_load_dwordx4 v36, s[16:19], s83 offen  lds
    s_add_u32 s83, s7, 696320
    s_mov_b32 m0, 10240
    s_nop 0
    buffer_load_dwordx4 v32, s[16:19], s83 offen  lds
    s_mov_b32 m0, 11264
    s_nop 0
    buffer_load_dwordx4 v33, s[16:19], s83 offen  lds
    s_mov_b32 m0, 12288
    s_nop 0
    buffer_load_dwordx4 v34, s[16:19], s83 offen  lds
    s_mov_b32 m0, 13312
    s_nop 0
    buffer_load_dwordx4 v35, s[16:19], s83 offen  lds
    s_mov_b32 m0, 14336
    s_nop 0
    buffer_load_dwordx4 v36, s[16:19], s83 offen  lds
    s_add_u32 s83, s7, 737280
    s_mov_b32 m0, 15360
    s_nop 0
    buffer_load_dwordx4 v32, s[16:19], s83 offen  lds
    s_mov_b32 m0, 16384
    s_nop 0
    buffer_load_dwordx4 v33, s[16:19], s83 offen  lds
    s_mov_b32 m0, 17408
    s_nop 0
    buffer_load_dwordx4 v34, s[16:19], s83 offen  lds
    s_mov_b32 m0, 18432
    s_nop 0
    buffer_load_dwordx4 v35, s[16:19], s83 offen  lds
    s_mov_b32 m0, 19456
    s_nop 0
    buffer_load_dwordx4 v36, s[16:19], s83 offen  lds
    s_add_u32 s83, s7, 778240
    s_mov_b32 m0, 20480
    s_nop 0
    buffer_load_dwordx4 v32, s[16:19], s83 offen  lds
    s_mov_b32 m0, 21504
    s_nop 0
    buffer_load_dwordx4 v33, s[16:19], s83 offen  lds
    s_mov_b32 m0, 22528
    s_nop 0
    buffer_load_dwordx4 v34, s[16:19], s83 offen  lds
    s_mov_b32 m0, 23552
    s_nop 0
    buffer_load_dwordx4 v35, s[16:19], s83 offen  lds
    s_mov_b32 m0, 24576
    s_nop 0
    buffer_load_dwordx4 v36, s[16:19], s83 offen  lds
L_h_nob2c:
    s_mul_i32 s30, s62, 81920
    s_add_u32 s30, s30, s7
    s_add_u32 s31, s30, 40960
    v_subrev_u32 v2, 256, v0
    v_mul_u32_u24 v3, 205, v2
    v_lshrrev_b32 v3, 11, v3
    v_mul_u32_u24 v3, 1120, v3
    v_lshl_add_u32 v174, v2, 4, v3
    s_and_b32 s70, s59, 1
    s_mul_i32 s70, s70, 320
    s_add_u32 s70, s70, 256
    v_add_u32 v2, s70, v1
    v_mul_u32_u24 v3, 205, v2
    v_lshrrev_b32 v3, 11, v3
    v_mul_u32_u24 v3, 1120, v3
    v_lshl_add_u32 v175, v2, 4, v3
    s_cmp_ge_u32 s59, 2
    s_cselect_b32 s72, 15, 23
    v_min_u32 v2, s72, v1
    v_lshrrev_b32 v3, 3, v2
    v_and_b32 v2, 7, v2
    v_lshl_add_u32 v2, v3, 5, v2
    s_mul_i32 s70, s63, 80
    s_lshl3_add_u32 s70, s59, s70
    v_add_u32 v2, s70, v2
    v_mul_u32_u24 v2, 128, v2
    v_add_u32 v170, 18350080, v2
    s_mul_i32 s70, s66, 128
    s_add_u32 s70, s70, 18350080
    v_mov_b32 v171, s70
    s_lshl_b32 s70, s56, 9
    v_and_b32 v2, 31, v1
    v_lshrrev_b32 v3, 5, v1
    v_lshlrev_b32 v206, 3, v2
    v_lshlrev_b32 v4, 4, v2
    v_lshl_add_u32 v205, v3, 15, v4
    v_add_u32 v4, s70, v4
    v_lshl_add_u32 v5, v3, 12, v4
    v_add_u32 v201, 83712, v5
    v_add_u32 v202, 91904, v4
    v_lshl_add_u32 v197, v3, 13, v4
    v_add_u32 v197, 59136, v197
    v_lshlrev_b32 v5, 9, v3
    v_sub_u32 v5, v4, v5
    v_add_u32 v198, 75520, v5
    v_bfe_u32 v4, v1, 2, 2
    v_lshl_add_u32 v4, v3, 2, v4
    v_lshlrev_b32 v4, 4, v4
    v_bfe_u32 v5, v1, 1, 1
    v_mul_u32_u24 v5, 8256, v5
    v_and_b32 v6, 1, v1
    v_lshl_add_u32 v5, v6, 3, v5
    s_and_b32 s71, s68, 1
    s_lshl_b32 s72, s71, 3
    s_add_u32 s72, s72, 16512
    v_mov_b32 v6, s72
    v_and_b32 v7, 16, v1
    v_cmp_ne_u32 vcc, 0, v7
    s_nop 1
    v_cndmask_b32 v5, v5, v6, vcc
    s_add_u32 s70, s70, 36352
    v_add3_u32 v5, v5, v4, s70
    v_and_b32 v7, 2, v1
    v_sub_u32 v7, 2, v7
    v_lshl_add_u32 v4, v7, 2, v4
    v_and_b32 v7, 19, v1
    v_cmp_lt_u32 vcc, 16, v7
    s_add_u32 s70, s56, 1
    s_cmp_eq_u32 s69, 0
    s_cselect_b32 s77, s70, 99
    s_cmp_gt_u32 s77, 0
    s_cselect_b32 s70, 24576, 0
    s_add_u32 s70, s70, 32960
    s_cmp_gt_u32 s77, 1
    s_cselect_b32 s70, 58048, s70
    v_add_u32 v6, s70, v4
    v_cndmask_b32 v190, v5, v6, vcc
    v_subrev_u32 v5, 1024, v5
    s_cmp_gt_u32 s77, 2
    s_cselect_b32 s70, 24576, 0
    s_add_u32 s70, s70, 32960
    s_cmp_gt_u32 s77, 3
    s_cselect_b32 s70, 58048, s70
    v_add_u32 v6, s70, v4
    v_cndmask_b32 v191, v5, v6, vcc
    v_subrev_u32 v5, 1024, v5
    s_cmp_gt_u32 s77, 4
    s_cselect_b32 s70, 24576, 0
    s_add_u32 s70, s70, 32960
    s_cmp_gt_u32 s77, 5
    s_cselect_b32 s70, 58048, s70
    v_add_u32 v6, s70, v4
    v_cndmask_b32 v192, v5, v6, vcc
    v_subrev_u32 v5, 1024, v5
    s_cmp_gt_u32 s77, 6
    s_cselect_b32 s70, 24576, 0
    s_add_u32 s70, s70, 32960
    s_cmp_gt_u32 s77, 7
    s_cselect_b32 s70, 58048, s70
    v_add_u32 v6, s70, v4
    v_cndmask_b32 v193, v5, v6, vcc
    v_subrev_u32 v5, 1024, v5
    s_cmp_gt_u32 s77, 8
    s_cselect_b32 s70, 24576, 0
    s_add_u32 s70, s70, 32960
    s_cmp_gt_u32 s77, 9
    s_cselect_b32 s70, 58048, s70
    v_add_u32 v6, s70, v4
    v_cndmask_b32 v194, v5, v6, vcc
    v_subrev_u32 v5, 1024, v5
    s_mov_b32 s78, 0
    s_cmp_eq_u32 s71, 0
    s_cselect_b32 s72, -1, 0
    s_cselect_b32 s73, 0, -1
    v_cmp_eq_u32 vcc, 0, v3
    v_mov_b32 v5, s72
    v_mov_b32 v6, s73
    v_cndmask_b32 v203, 0, v5, vcc
    v_cndmask_b32 v204, 0, v6, vcc
    v_cndmask_b32 v182, v5, 0, vcc
    v_cndmask_b32 v183, v6, 0, vcc
    s_mov_b32 s74, 6554
    v_mul_u32_u24 v3, s74, v0
    v_lshrrev_b32 v3, 16, v3
    v_mul_u32_u24 v3, 1120, v3
    v_lshl_add_u32 v208, v0, 4, v3
    v_add_u32 v2, 512, v0
    v_mul_u32_u24 v3, s74, v2
    v_lshrrev_b32 v3, 16, v3
    v_mul_u32_u24 v3, 1120, v3
    v_lshl_add_u32 v209, v2, 4, v3
    v_add_u32 v2, 1024, v0
    v_mul_u32_u24 v3, s74, v2
    v_lshrrev_b32 v3, 16, v3
    v_mul_u32_u24 v3, 1120, v3
    v_lshl_add_u32 v210, v2, 4, v3
    v_add_u32 v2, 1536, v0
    v_mul_u32_u24 v3, s74, v2
    v_lshrrev_b32 v3, 16, v3
    v_mul_u32_u24 v3, 1120, v3
    v_lshl_add_u32 v211, v2, 4, v3
    v_add_u32 v2, 2048, v0
    v_mul_u32_u24 v3, s74, v2
    v_lshrrev_b32 v3, 16, v3
    v_mul_u32_u24 v3, 1120, v3
    v_lshl_add_u32 v212, v2, 4, v3
    s_lshl_b32 s72, s56, 10
    s_add_u32 s24, s72, 87040
    s_add_u32 s25, s24, 73728
    s_sub_u32 s72, s72, 3072
    s_min_u32 s25, s25, s72
    s_add_u32 s26, s7, 327680
    v_and_b32 v2, 31, v1
    v_lshrrev_b32 v3, 5, v1
    v_lshlrev_b32 v3, 2, v3
    v_sub_u32 v2, v2, v3
    v_mov_b32 v3, 0xf149f2ca
    v_cmp_gt_i32 vcc, 0, v2
    v_cmp_gt_i32 s[80:81], 1, v2
    s_nop 0
    v_cndmask_b32 v224, 0, v3, vcc
    v_cndmask_b32 v225, 0, v3, s[80:81]
    v_cmp_gt_i32 vcc, 2, v2
    v_cmp_gt_i32 s[80:81], 3, v2
    v_xor_b32 v240, v3, v224
    v_xor_b32 v241, v3, v225
    v_cndmask_b32 v226, 0, v3, vcc
    v_cndmask_b32 v227, 0, v3, s[80:81]
    v_cmp_gt_i32 vcc, 8, v2
    v_cmp_gt_i32 s[80:81], 9, v2
    v_xor_b32 v242, v3, v226
    v_xor_b32 v243, v3, v227
    v_cndmask_b32 v228, 0, v3, vcc
    v_cndmask_b32 v229, 0, v3, s[80:81]
    v_cmp_gt_i32 vcc, 10, v2
    v_cmp_gt_i32 s[80:81], 11, v2
    v_xor_b32 v244, v3, v228
    v_xor_b32 v245, v3, v229
    v_cndmask_b32 v230, 0, v3, vcc
    v_cndmask_b32 v231, 0, v3, s[80:81]
    v_cmp_gt_i32 vcc, 16, v2
    v_cmp_gt_i32 s[80:81], 17, v2
    v_xor_b32 v246, v3, v230
    v_xor_b32 v247, v3, v231
    v_cndmask_b32 v232, 0, v3, vcc
    v_cndmask_b32 v233, 0, v3, s[80:81]
    v_cmp_gt_i32 vcc, 18, v2
    v_cmp_gt_i32 s[80:81], 19, v2
    v_xor_b32 v248, v3, v232
    v_xor_b32 v249, v3, v233
    v_cndmask_b32 v234, 0, v3, vcc
    v_cndmask_b32 v235, 0, v3, s[80:81]
    v_cmp_gt_i32 vcc, 24, v2
    v_cmp_gt_i32 s[80:81], 25, v2
    v_xor_b32 v250, v3, v234
    v_xor_b32 v251, v3, v235
    v_cndmask_b32 v236, 0, v3, vcc
    v_cndmask_b32 v237, 0, v3, s[80:81]
    v_cmp_gt_i32 vcc, 26, v2
    v_cmp_gt_i32 s[80:81], 27, v2
    v_xor_b32 v252, v3, v236
    v_xor_b32 v253, v3, v237
    v_cndmask_b32 v238, 0, v3, vcc
    v_cndmask_b32 v239, 0, v3, s[80:81]
    v_xor_b32 v254, v3, v238
    v_xor_b32 v255, v3, v239
    s_waitcnt vmcnt(0)
    s_branch L_join_a
L_c_idle:
    v_and_b32 v2, 31, v1
    v_lshrrev_b32 v3, 5, v1
    v_lshlrev_b32 v3, 2, v3
    v_sub_u32 v2, v2, v3
    v_mov_b32 v3, 0xf149f2ca
    v_cmp_gt_i32 vcc, 0, v2
    v_cmp_gt_i32 s[80:81], 1, v2
    s_nop 0
    v_cndmask_b32 v224, 0, v3, vcc
    v_cndmask_b32 v225, 0, v3, s[80:81]
    v_cmp_gt_i32 vcc, 2, v2
    v_cmp_gt_i32 s[80:81], 3, v2
    v_xor_b32 v240, v3, v224
    v_xor_b32 v241, v3, v225
    v_cndmask_b32 v226, 0, v3, vcc
    v_cndmask_b32 v227, 0, v3, s[80:81]
    v_cmp_gt_i32 vcc, 8, v2
    v_cmp_gt_i32 s[80:81], 9, v2
    v_xor_b32 v242, v3, v226
    v_xor_b32 v243, v3, v227
    v_cndmask_b32 v228, 0, v3, vcc
    v_cndmask_b32 v229, 0, v3, s[80:81]
    v_cmp_gt_i32 vcc, 10, v2
    v_cmp_gt_i32 s[80:81], 11, v2
    v_xor_b32 v244, v3, v228
    v_xor_b32 v245, v3, v229
    v_cndmask_b32 v230, 0, v3, vcc
    v_cndmask_b32 v231, 0, v3, s[80:81]
    v_cmp_gt_i32 vcc, 16, v2
    v_cmp_gt_i32 s[80:81], 17, v2
    v_xor_b32 v246, v3, v230
    v_xor_b32 v247, v3, v231
    v_cndmask_b32 v232, 0, v3, vcc
    v_cndmask_b32 v233, 0, v3, s[80:81]
    v_cmp_gt_i32 vcc, 18, v2
    v_cmp_gt_i32 s[80:81], 19, v2
    v_xor_b32 v248, v3, v232
    v_xor_b32 v249, v3, v233
    v_cndmask_b32 v234, 0, v3, vcc
    v_cndmask_b32 v235, 0, v3, s[80:81]
    v_cmp_gt_i32 vcc, 24, v2
    v_cmp_gt_i32 s[80:81], 25, v2
    v_xor_b32 v250, v3, v234
    v_xor_b32 v251, v3, v235
    v_cndmask_b32 v236, 0, v3, vcc
    v_cndmask_b32 v237, 0, v3, s[80:81]
    v_cmp_gt_i32 vcc, 26, v2
    v_cmp_gt_i32 s[80:81], 27, v2
    v_xor_b32 v252, v3, v236
    v_xor_b32 v253, v3, v237
    v_cndmask_b32 v238, 0, v3, vcc
    v_cndmask_b32 v239, 0, v3, s[80:81]
    v_xor_b32 v254, v3, v238
    v_xor_b32 v255, v3, v239
    s_lshl_b32 s70, s56, 9
    v_and_b32 v2, 31, v1
    v_lshrrev_b32 v3, 5, v1
    v_lshlrev_b32 v206, 3, v2
    v_lshlrev_b32 v4, 4, v2
    v_lshl_add_u32 v205, v3, 15, v4
    v_add_u32 v4, s70, v4
    v_lshl_add_u32 v5, v3, 12, v4
    v_add_u32 v201, 83712, v5
    v_add_u32 v202, 91904, v4
    v_lshl_add_u32 v197, v3, 13, v4
    v_add_u32 v197, 59136, v197
    v_lshlrev_b32 v5, 9, v3
    v_sub_u32 v5, v4, v5
    v_add_u32 v198, 75520, v5
    v_bfe_u32 v4, v1, 2, 2
    v_lshl_add_u32 v4, v3, 2, v4
    v_lshlrev_b32 v4, 4, v4
    v_bfe_u32 v5, v1, 1, 1
    v_mul_u32_u24 v5, 8256, v5
    v_and_b32 v6, 1, v1
    v_lshl_add_u32 v5, v6, 3, v5
    s_and_b32 s71, s68, 1
    s_lshl_b32 s72, s71, 3
    s_add_u32 s72, s72, 16512
    v_mov_b32 v6, s72
    v_and_b32 v7, 16, v1
    v_cmp_ne_u32 vcc, 0, v7
    s_nop 1
    v_cndmask_b32 v5, v5, v6, vcc
    s_add_u32 s70, s70, 36352
    v_add3_u32 v5, v5, v4, s70
    v_and_b32 v7, 2, v1
    v_sub_u32 v7, 2, v7
    v_lshl_add_u32 v4, v7, 2, v4
    v_and_b32 v7, 19, v1
    v_cmp_lt_u32 vcc, 16, v7
    s_add_u32 s70, s56, 1
    s_cmp_eq_u32 s69, 0
    s_cselect_b32 s77, s70, 99
    s_cmp_gt_u32 s77, 0
    s_cselect_b32 s70, 24576, 0
    s_add_u32 s70, s70, 32960
    s_cmp_gt_u32 s77, 1
    s_cselect_b32 s70, 58048, s70
    v_add_u32 v6, s70, v4
    v_cndmask_b32 v190, v5, v6, vcc
    v_subrev_u32 v5, 1024, v5
    s_cmp_gt_u32 s77, 2
    s_cselect_b32 s70, 24576, 0
    s_add_u32 s70, s70, 32960
    s_cmp_gt_u32 s77, 3
    s_cselect_b32 s70, 58048, s70
    v_add_u32 v6, s70, v4
    v_cndmask_b32 v191, v5, v6, vcc
    v_subrev_u32 v5, 1024, v5
    s_cmp_gt_u32 s77, 4
    s_cselect_b32 s70, 24576, 0
    s_add_u32 s70, s70, 32960
    s_cmp_gt_u32 s77, 5
    s_cselect_b32 s70, 58048, s70
    v_add_u32 v6, s70, v4
    v_cndmask_b32 v192, v5, v6, vcc
    v_subrev_u32 v5, 1024, v5
    s_cmp_gt_u32 s77, 6
    s_cselect_b32 s70, 24576, 0
    s_add_u32 s70, s70, 32960
    s_cmp_gt_u32 s77, 7
    s_cselect_b32 s70, 58048, s70
    v_add_u32 v6, s70, v4
    v_cndmask_b32 v193, v5, v6, vcc
    v_subrev_u32 v5, 1024, v5
    s_cmp_gt_u32 s77, 8
    s_cselect_b32 s70, 24576, 0
    s_add_u32 s70, s70, 32960
    s_cmp_gt_u32 s77, 9
    s_cselect_b32 s70, 58048, s70
    v_add_u32 v6, s70, v4
    v_cndmask_b32 v194, v5, v6, vcc
    v_subrev_u32 v5, 1024, v5
    s_mov_b32 s78, 0
    s_cmp_eq_u32 s71, 0
    s_cselect_b32 s72, -1, 0
    s_cselect_b32 s73, 0, -1
    v_cmp_eq_u32 vcc, 0, v3
    v_mov_b32 v5, s72
    v_mov_b32 v6, s73
    v_cndmask_b32 v203, 0, v5, vcc
    v_cndmask_b32 v204, 0, v6, vcc
    v_cndmask_b32 v182, v5, 0, vcc
    v_cndmask_b32 v183, v6, 0, vcc
    s_mov_b32 s74, 6554
    v_mul_u32_u24 v3, s74, v0
    v_lshrrev_b32 v3, 16, v3
    v_mul_u32_u24 v3, 1120, v3
    v_lshl_add_u32 v208, v0, 4, v3
    v_add_u32 v2, 512, v0
    v_mul_u32_u24 v3, s74, v2
    v_lshrrev_b32 v3, 16, v3
    v_mul_u32_u24 v3, 1120, v3
    v_lshl_add_u32 v209, v2, 4, v3
    v_add_u32 v2, 1024, v0
    v_mul_u32_u24 v3, s74, v2
    v_lshrrev_b32 v3, 16, v3
    v_mul_u32_u24 v3, 1120, v3
    v_lshl_add_u32 v210, v2, 4, v3
    v_add_u32 v2, 1536, v0
    v_mul_u32_u24 v3, s74, v2
    v_lshrrev_b32 v3, 16, v3
    v_mul_u32_u24 v3, 1120, v3
    v_lshl_add_u32 v211, v2, 4, v3
    v_add_u32 v2, 2048, v0
    v_mul_u32_u24 v3, s74, v2
    v_lshrrev_b32 v3, 16, v3
    v_mul_u32_u24 v3, 1120, v3
    v_lshl_add_u32 v212, v2, 4, v3
    s_lshr_b32 s70, s68, 1
    s_mul_i32 s70, s70, 5
    s_and_b32 s71, s68, 1
    s_lshl_b32 s72, s71, 1
    s_add_u32 s72, s72, s70
    s_add_u32 s73, s72, 2
    s_lshr_b32 s72, s72, 3
    s_lshr_b32 s73, s73, 3
    s_lshr_b32 s74, s68, 2
    s_mul_i32 s0, s74, 10
    s_lshr_b32 s0, s0, 3
    s_sub_u32 s72, s72, s0
    s_sub_u32 s73, s73, s0
    s_cmp_eq_u32 s69, 0
    s_cselect_b32 s0, 2, 4
    v_lshrrev_b32 v2, 1, v1
    v_min_u32 v2, s0, v2
    v_and_b32 v4, 1, v1
    v_cmp_eq_u32 vcc, 1, v4
    v_mov_b32 v4, s72
    v_mov_b32 v5, s73
    v_cndmask_b32 v4, v4, v5, vcc
    v_lshl_add_u32 v2, v2, 1, v4
    s_lshl_b32 s0, s74, 5
    s_lshl_b32 s74, s69, 2
    s_add_u32 s74, s74, s56
    s_add_u32 s0, s0, s74
    s_lshl_b32 s0, s0, 8
    s_add_u32 s0, s0, 17825792
    v_lshl_add_u32 v207, v2, 4, s0
    s_lshl_b32 s1, s62, 2
    s_add_u32 s1, s1, s56
    s_lshl_b32 s1, s1, 9
    s_add_u32 s1, s1, 18612224
    v_and_b32 v2, 15, v1
    v_lshl_add_u32 v199, v2, 5, s1
    s_mul_i32 s71, s71, 3
    s_add_u32 s0, s70, s71
    s_add_u32 s1, s70, 2
    s_lshl_b32 s0, s0, 15
    s_lshl_b32 s1, s1, 15
    s_lshl_b32 s74, s74, 10
    s_add_u32 s0, s0, s74
    s_add_u32 s1, s1, s74
    v_lshlrev_b32 v14, 4, v1
    v_bfrev_b32 v15, 1
    s_cmp_eq_u32 s69, 0
    s_cselect_b64 vcc, -1, 0
    v_cndmask_b32 v15, v14, v15, vcc
    s_lshl_b32 s75, s56, 10
    s_lshl_b32 s72, s56, 10
    s_add_u32 s24, s72, 87040
    s_add_u32 s25, s24, 73728
    s_sub_u32 s72, s72, 3072
    s_min_u32 s25, s25, s72
    s_add_u32 s26, s7, 327680
    s_waitcnt vmcnt(0)
    s_barrier
    v_mov_b32 v62, 0
    buffer_load_dwordx2 v[60:61], v62, s[48:51], 0 offen sc1
    buffer_load_dword v63, v207, s[52:55], 0 offen sc1
    buffer_load_dword v63, v199, s[52:55], 0 offen sc1
    v_and_b32 v2, 7, v0
    v_lshrrev_b32 v3, 3, v0
    v_mul_u32_u24 v4, 1296, v2
    v_lshl_add_u32 v4, v3, 2, v4
    v_add_u32 v4, 98304, v4
    ds_read_b32 v128, v4 offset:160
    ds_read_b32 v129, v4 offset:320
    ds_read_b32 v130, v4 offset:480
    ds_read_b32 v131, v4 offset:656
    ds_read_b32 v132, v4 offset:816
    ds_read_b32 v133, v4 offset:976
    ds_read_b32 v134, v4 offset:1136
    ds_read_b32 v135, v4 offset:1296
    ds_read_b32 v136, v4 offset:1456
    ds_read_b32 v137, v4 offset:1616
    ds_read_b32 v138, v4 offset:1776
    ds_read_b32 v144, v4 offset:11024
    ds_read_b32 v145, v4 offset:11184
    ds_read_b32 v146, v4 offset:11344
    ds_read_b32 v147, v4 offset:11504
    ds_read_b32 v148, v4 offset:11664
    ds_read_b32 v149, v4 offset:11824
    ds_read_b32 v150, v4 offset:11984
    ds_read_b32 v151, v4 offset:12144
    v_lshlrev_b32 v3, 13, v3
    v_sub_u32 v2, 7, v2
    v_lshl_add_u32 v3, v2, 4, v3
    v_and_b32 v2, 31, v0
    v_lshrrev_b32 v4, 5, v0
    v_mul_u32_u24 v5, 320, v2
    v_lshl_add_u32 v5, v4, 2, v5
    v_add_u32 v5, 98432, v5
    v_add_u32 v6, 3, v2
    v_lshrrev_b32 v6, 2, v6
    v_lshl_add_u32 v6, v6, 4, v5
    v_add_u32 v7, 2, v2
    v_lshrrev_b32 v7, 2, v7
    v_lshl_add_u32 v7, v7, 4, v5
    v_lshrrev_b32 v188, 2, v2
    v_lshl_add_u32 v5, v188, 4, v5
    ds_read_b32 v7, v7 offset:160
    ds_read_b32 v188, v6 offset:320
    ds_read_b32 v6, v6 offset:480
    ds_read_b32 v189, v5 offset:656
    ds_read_b32 v195, v5 offset:816
    ds_read_b32 v196, v5 offset:11024
    ds_read_b32 v5, v5 offset:11184
    v_lshlrev_b32 v2, 2, v2
    v_sub_u32 v2, 262268, v2
    v_lshl_add_u32 v2, v4, 13, v2
    v_lshlrev_b32 v174, 16, v8
    v_lshlrev_b32 v175, 16, v10
    v_and_b32 v176, 0xffff0000, v8
    v_and_b32 v177, 0xffff0000, v10
    v_lshlrev_b32 v178, 16, v9
    v_lshlrev_b32 v179, 16, v11
    v_and_b32 v180, 0xffff0000, v9
    v_and_b32 v181, 0xffff0000, v11
    s_mul_i32 s70, s63, 327680
    s_lshl_b32 s71, s62, 7
    s_sub_u32 s70, s70, s71
    s_add_u32 s70, s70, 8392576
    s_waitcnt lgkmcnt(15)
    v_lshlrev_b32 v152, 16, v128
    v_and_b32 v153, 0xffff0000, v128
    v_lshlrev_b32 v154, 16, v129
    v_and_b32 v155, 0xffff0000, v129
    v_lshlrev_b32 v156, 16, v130
    v_and_b32 v157, 0xffff0000, v130
    v_lshlrev_b32 v158, 16, v131
    v_and_b32 v159, 0xffff0000, v131
    v_lshlrev_b32 v160, 16, v132
    v_and_b32 v161, 0xffff0000, v132
    v_lshlrev_b32 v162, 16, v133
    v_and_b32 v163, 0xffff0000, v133
    v_lshlrev_b32 v164, 16, v134
    v_and_b32 v165, 0xffff0000, v134
    v_lshlrev_b32 v166, 16, v135
    v_and_b32 v167, 0xffff0000, v135
    v_lshlrev_b32 v168, 16, v136
    v_and_b32 v169, 0xffff0000, v136
    v_lshlrev_b32 v170, 16, v137
    v_and_b32 v171, 0xffff0000, v137
    v_lshlrev_b32 v172, 16, v138
    v_and_b32 v173, 0xffff0000, v138
    v_pk_mul_f32 v[128:129], v[158:159], v[174:175]
    v_pk_mul_f32 v[130:131], v[160:161], v[174:175]
    v_pk_mul_f32 v[132:133], v[162:163], v[174:175]
    v_pk_mul_f32 v[134:135], v[164:165], v[174:175]
    v_pk_mul_f32 v[136:137], v[166:167], v[174:175]
    v_pk_mul_f32 v[138:139], v[168:169], v[174:175]
    v_pk_mul_f32 v[140:141], v[170:171], v[174:175]
    v_pk_mul_f32 v[142:143], v[172:173], v[174:175]
    v_pk_fma_f32 v[128:129], v[156:157], v[176:177], v[128:129]
    v_pk_fma_f32 v[130:131], v[158:159], v[176:177], v[130:131]
    v_pk_fma_f32 v[132:133], v[160:161], v[176:177], v[132:133]
    v_pk_fma_f32 v[134:135], v[162:163], v[176:177], v[134:135]
    v_pk_fma_f32 v[136:137], v[164:165], v[176:177], v[136:137]
    v_pk_fma_f32 v[138:139], v[166:167], v[176:177], v[138:139]
    v_pk_fma_f32 v[140:141], v[168:169], v[176:177], v[140:141]
    v_pk_fma_f32 v[142:143], v[170:171], v[176:177], v[142:143]
    v_pk_fma_f32 v[128:129], v[154:155], v[178:179], v[128:129]
    v_pk_fma_f32 v[130:131], v[156:157], v[178:179], v[130:131]
    v_pk_fma_f32 v[132:133], v[158:159], v[178:179], v[132:133]
    v_pk_fma_f32 v[134:135], v[160:161], v[178:179], v[134:135]
    v_pk_fma_f32 v[136:137], v[162:163], v[178:179], v[136:137]
    v_pk_fma_f32 v[138:139], v[164:165], v[178:179], v[138:139]
    v_pk_fma_f32 v[140:141], v[166:167], v[178:179], v[140:141]
    v_pk_fma_f32 v[142:143], v[168:169], v[178:179], v[142:143]
    v_pk_fma_f32 v[128:129], v[152:153], v[180:181], v[128:129]
    v_pk_fma_f32 v[130:131], v[154:155], v[180:181], v[130:131]
    v_pk_fma_f32 v[132:133], v[156:157], v[180:181], v[132:133]
    v_pk_fma_f32 v[134:135], v[158:159], v[180:181], v[134:135]
    v_pk_fma_f32 v[136:137], v[160:161], v[180:181], v[136:137]
    v_pk_fma_f32 v[138:139], v[162:163], v[180:181], v[138:139]
    v_pk_fma_f32 v[140:141], v[164:165], v[180:181], v[140:141]
    v_pk_fma_f32 v[142:143], v[166:167], v[180:181], v[142:143]
    s_waitcnt lgkmcnt(7)
    v_lshlrev_b32 v152, 16, v144
    v_and_b32 v153, 0xffff0000, v144
    v_lshlrev_b32 v154, 16, v145
    v_and_b32 v155, 0xffff0000, v145
    v_lshlrev_b32 v156, 16, v146
    v_and_b32 v157, 0xffff0000, v146
    v_lshlrev_b32 v158, 16, v147
    v_and_b32 v159, 0xffff0000, v147
    v_lshlrev_b32 v160, 16, v148
    v_and_b32 v161, 0xffff0000, v148
    v_lshlrev_b32 v162, 16, v149
    v_and_b32 v163, 0xffff0000, v149
    v_lshlrev_b32 v164, 16, v150
    v_and_b32 v165, 0xffff0000, v150
    v_lshlrev_b32 v166, 16, v151
    v_and_b32 v167, 0xffff0000, v151
    v_pk_mul_f32 v[128:129], v[128:129], v[152:153]
    v_pk_mul_f32 v[130:131], v[130:131], v[154:155]
    v_pk_mul_f32 v[132:133], v[132:133], v[156:157]
    v_pk_mul_f32 v[134:135], v[134:135], v[158:159]
    v_pk_mul_f32 v[136:137], v[136:137], v[160:161]
    v_pk_mul_f32 v[138:139], v[138:139], v[162:163]
    v_pk_mul_f32 v[140:141], v[140:141], v[164:165]
    v_pk_mul_f32 v[142:143], v[142:143], v[166:167]
    v_cvt_pk_bf16_f32 v168, v142, v140
    v_cvt_pk_bf16_f32 v169, v138, v136
    v_cvt_pk_bf16_f32 v170, v134, v132
    v_cvt_pk_bf16_f32 v171, v130, v128
    v_cvt_pk_bf16_f32 v172, v143, v141
    v_cvt_pk_bf16_f32 v173, v139, v137
    v_cvt_pk_bf16_f32 v174, v135, v133
    v_cvt_pk_bf16_f32 v175, v131, v129
    v_lshlrev_b32 v146, 16, v184
    v_lshlrev_b32 v147, 16, v186
    v_and_b32 v148, 0xffff0000, v184
    v_and_b32 v149, 0xffff0000, v186
    v_lshlrev_b32 v150, 16, v185
    v_lshlrev_b32 v151, 16, v187
    v_and_b32 v152, 0xffff0000, v185
    v_and_b32 v153, 0xffff0000, v187
    s_waitcnt lgkmcnt(0)
    v_lshlrev_b32 v132, 16, v7
    v_and_b32 v133, 0xffff0000, v7
    v_lshlrev_b32 v134, 16, v188
    v_and_b32 v135, 0xffff0000, v188
    v_lshlrev_b32 v136, 16, v6
    v_and_b32 v137, 0xffff0000, v6
    v_lshlrev_b32 v138, 16, v189
    v_and_b32 v139, 0xffff0000, v189
    v_lshlrev_b32 v140, 16, v195
    v_and_b32 v141, 0xffff0000, v195
    v_lshlrev_b32 v142, 16, v196
    v_and_b32 v143, 0xffff0000, v196
    v_lshlrev_b32 v144, 16, v5
    v_and_b32 v145, 0xffff0000, v5
    v_pk_mul_f32 v[128:129], v[138:139], v[146:147]
    v_pk_mul_f32 v[130:131], v[140:141], v[146:147]
    v_pk_fma_f32 v[128:129], v[136:137], v[148:149], v[128:129]
    v_pk_fma_f32 v[130:131], v[138:139], v[148:149], v[130:131]
    v_pk_fma_f32 v[128:129], v[134:135], v[150:151], v[128:129]
    v_pk_fma_f32 v[130:131], v[136:137], v[150:151], v[130:131]
    v_pk_fma_f32 v[128:129], v[132:133], v[152:153], v[128:129]
    v_pk_fma_f32 v[130:131], v[134:135], v[152:153], v[130:131]
    v_pk_mul_f32 v[128:129], v[128:129], v[142:143]
    v_pk_mul_f32 v[130:131], v[130:131], v[144:145]
    v_cvt_pk_bf16_f32 v176, v130, v128
    v_cvt_pk_bf16_f32 v177, v131, v129
    v_add_u32 v178, s70, v3
    v_add_u32 v179, s70, v2
    s_movk_i32 s71, 0x1000
    buffer_store_dwordx4 v[168:171], v178, s[52:55], 0 offen sc1
    buffer_store_dwordx4 v[172:175], v178, s[52:55], s71 offen sc1
    buffer_store_dword v176, v179, s[52:55], 0 offen sc1
    buffer_store_dword v177, v179, s[52:55], s71 offen sc1
    s_barrier
    s_waitcnt vmcnt(0)
    s_mov_b32 s76, 0
L_nonr_38:
    v_readfirstlane_b32 s60, v60
    v_readfirstlane_b32 s61, v61
    s_cmp_eq_u32 s60, 0
    s_cbranch_scc1 L_non_37
L_nond_39:
    s_lshl_b32 s70, s63, 2
    s_add_u32 s70, s70, s56
    s_lshl_b32 s70, s70, 5
    s_add_u32 s70, s70, s62
    s_mul_i32 s70, s70, 8
    s_add_u32 s70, s70, 18087936
    v_mov_b32 v2, s60
    v_mov_b32 v3, s61
    v_mov_b32 v4, s70
    s_mov_b64 exec, 1
    buffer_store_dwordx2 v[2:3], v4, s[52:55], 0 offen sc1
    s_mov_b64 exec, -1
    s_sub_u32 s70, s58, 30
    s_lshl_b32 s70, s70, 2
    s_add_u32 s70, s70, s56
    s_lshl_b32 s70, s70, 6
    v_add_u32 v4, s70, v1
    s_lshl_b32 s71, s57, 9
    v_add_u32 v2, s71, v4
    s_waitcnt vmcnt(1)
    v_and_b32 v2, 4095, v2
    v_add_u32 v3, 4480, v2
    v_subrev_u32 v5, 6400, v3
    v_min_u32 v3, v3, v5
    v_add_u32 v2, 512, v2
    v_lshlrev_b32 v3, 7, v3
    buffer_load_dword v63, v3, s[16:19], 0 offen
    s_waitcnt vmcnt(1)
    v_and_b32 v2, 4095, v2
    v_add_u32 v3, 4480, v2
    v_subrev_u32 v5, 6400, v3
    v_min_u32 v3, v3, v5
    v_add_u32 v2, 512, v2
    v_lshlrev_b32 v3, 7, v3
    buffer_load_dword v63, v3, s[16:19], 0 offen
    s_waitcnt vmcnt(1)
    v_and_b32 v2, 4095, v2
    v_add_u32 v3, 4480, v2
    v_subrev_u32 v5, 6400, v3
    v_min_u32 v3, v3, v5
    v_add_u32 v2, 512, v2
    v_lshlrev_b32 v3, 7, v3
    buffer_load_dword v63, v3, s[16:19], 0 offen
    s_waitcnt vmcnt(1)
    v_and_b32 v2, 4095, v2
    v_add_u32 v3, 4480, v2
    v_subrev_u32 v5, 6400, v3
    v_min_u32 v3, v3, v5
    v_add_u32 v2, 512, v2
    v_lshlrev_b32 v3, 7, v3
    buffer_load_dword v63, v3, s[16:19], 0 offen
    s_waitcnt vmcnt(1)
    v_and_b32 v2, 4095, v2
    v_add_u32 v3, 4480, v2
    v_subrev_u32 v5, 6400, v3
    v_min_u32 v3, v3, v5
    v_add_u32 v2, 512, v2
    v_lshlrev_b32 v3, 7, v3
    buffer_load_dword v63, v3, s[16:19], 0 offen
    s_waitcnt vmcnt(1)
    v_and_b32 v2, 4095, v2
    v_add_u32 v3, 4480, v2
    v_subrev_u32 v5, 6400, v3
    v_min_u32 v3, v3, v5
    v_add_u32 v2, 512, v2
    v_lshlrev_b32 v3, 7, v3
    buffer_load_dword v63, v3, s[16:19], 0 offen
    s_waitcnt vmcnt(1)
    v_and_b32 v2, 4095, v2
    v_add_u32 v3, 4480, v2
    v_subrev_u32 v5, 6400, v3
    v_min_u32 v3, v3, v5
    v_add_u32 v2, 512, v2
    v_lshlrev_b32 v3, 7, v3
    buffer_load_dword v63, v3, s[16:19], 0 offen
    s_waitcnt vmcnt(1)
    v_and_b32 v2, 4095, v2
    v_add_u32 v3, 4480, v2
    v_subrev_u32 v5, 6400, v3
    v_min_u32 v3, v3, v5
    v_add_u32 v2, 512, v2
    v_lshlrev_b32 v3, 7, v3
    buffer_load_dword v63, v3, s[16:19], 0 offen
    s_branch L_c_post
L_non_10:
    s_add_u32 s76, s76, 1
    s_cmp_lt_u32 s76, 0x40000
    s_cbranch_scc0 L_nond_12
    buffer_load_dwordx2 v[60:61], v62, s[48:51], 0 offen sc1
    s_waitcnt vmcnt(0)
    s_branch L_nonr_11
L_zp_15:
    v_mov_b32 v4, s60
    v_mov_b32 v5, s61
    s_waitcnt vmcnt(5)
    s_mov_b64 exec, 1
    buffer_store_dwordx2 v[4:5], v171, s[52:55], 0 offen sc1
    s_mov_b64 exec, -1
    s_branch L_zpr_16
L_cp_21:
    s_mov_b32 s76, 0
L_poll_40:
    buffer_load_dwordx2 v[172:173], v170, s[52:55], 0 offen sc1
    s_waitcnt vmcnt(0)
    v_cmp_ne_u32 vcc, s60, v172
    v_cmp_ne_u32 s[80:81], s61, v173
    s_nop 0
    s_or_b64 vcc, vcc, s[80:81]
    s_cbranch_vccz L_polld_41
    s_add_u32 s76, s76, 1
    s_cmp_lt_u32 s76, 0x40000
    s_cbranch_scc0 L_polld_41
    s_sleep 1
    s_branch L_poll_40
L_polld_41:
    s_branch L_cpr_22
L_cp_25:
    s_mov_b32 s76, 0
L_poll_42:
    buffer_load_dwordx2 v[10:11], v8, s[52:55], 0 offen sc1
    s_waitcnt vmcnt(0)
    v_cmp_ne_u32 vcc, s60, v10
    v_cmp_ne_u32 s[80:81], s61, v11
    s_nop 0
    s_or_b64 vcc, vcc, s[80:81]
    s_cbranch_vccz L_polld_43
    s_add_u32 s76, s76, 1
    s_cmp_lt_u32 s76, 0x40000
    s_cbranch_scc0 L_polld_43
    s_sleep 1
    s_branch L_poll_42
L_polld_43:
    s_branch L_cpr_26
L_non_32:
    s_add_u32 s76, s76, 1
    s_cmp_lt_u32 s76, 0x40000
    s_cbranch_scc0 L_nond_34
    buffer_load_dwordx2 v[22:23], v24, s[48:51], 0 offen sc1
    s_waitcnt vmcnt(0)
    s_branch L_nonr_33
L_cp_35:
    s_mov_b32 s76, 0
L_poll_44:
    buffer_load_dwordx2 v[14:15], v12, s[52:55], 0 offen sc1
    s_waitcnt vmcnt(0)
    v_cmp_ne_u32 vcc, s60, v14
    v_cmp_ne_u32 s[80:81], s61, v15
    s_nop 0
    s_or_b64 vcc, vcc, s[80:81]
    s_cbranch_vccz L_polld_45
    s_add_u32 s76, s76, 1
    s_cmp_lt_u32 s76, 0x40000
    s_cbranch_scc0 L_polld_45
    s_sleep 1
    s_branch L_poll_44
L_polld_45:
    s_branch L_cpr_36
L_non_37:
    s_add_u32 s76, s76, 1
    s_cmp_lt_u32 s76, 0x40000
    s_cbranch_scc0 L_nond_39
    buffer_load_dwordx2 v[60:61], v62, s[48:51], 0 offen sc1
    s_waitcnt vmcnt(0)
    s_branch L_nonr_38
L_end:
L_a2_fb:
    s_cmp_lg_u32 s78, 0
    s_cbranch_scc1 L_a2_ok
    s_mov_b32 s78, 1
    s_waitcnt vmcnt(0)
    v_and_b32 v2, 31, v1
    v_lshrrev_b32 v3, 5, v1
    v_lshlrev_b32 v3, 2, v3
    v_sub_u32 v2, v2, v3
    v_mov_b32 v3, 0xf149f2ca
    v_cmp_le_i32 vcc, 0, v2
    v_cmp_le_i32 s[80:81], 1, v2
    v_mov_b32 v208, 0
    v_mov_b32 v209, 0
    v_cndmask_b32 v224, v3, v208, vcc
    v_cndmask_b32 v240, v208, v3, vcc
    v_cndmask_b32 v225, v3, v209, s[80:81]
    v_cndmask_b32 v241, v209, v3, s[80:81]
    v_cmp_le_i32 vcc, 2, v2
    v_cmp_le_i32 s[80:81], 3, v2
    v_mov_b32 v210, 0
    v_mov_b32 v211, 0
    v_cndmask_b32 v226, v3, v210, vcc
    v_cndmask_b32 v242, v210, v3, vcc
    v_cndmask_b32 v227, v3, v211, s[80:81]
    v_cndmask_b32 v243, v211, v3, s[80:81]
    v_cmp_le_i32 vcc, 8, v2
    v_cmp_le_i32 s[80:81], 9, v2
    v_mov_b32 v212, 0
    v_mov_b32 v213, 0
    v_cndmask_b32 v228, v3, v212, vcc
    v_cndmask_b32 v244, v212, v3, vcc
    v_cndmask_b32 v229, v3, v213, s[80:81]
    v_cndmask_b32 v245, v213, v3, s[80:81]
    v_cmp_le_i32 vcc, 10, v2
    v_cmp_le_i32 s[80:81], 11, v2
    v_mov_b32 v214, 0
    v_mov_b32 v215, 0
    v_cndmask_b32 v230, v3, v214, vcc
    v_cndmask_b32 v246, v214, v3, vcc
    v_cndmask_b32 v231, v3, v215, s[80:81]
    v_cndmask_b32 v247, v215, v3, s[80:81]
    v_cmp_le_i32 vcc, 16, v2
    v_cmp_le_i32 s[80:81], 17, v2
    v_mov_b32 v216, 0
    v_mov_b32 v217, 0
    v_cndmask_b32 v232, v3, v216, vcc
    v_cndmask_b32 v248, v216, v3, vcc
    v_cndmask_b32 v233, v3, v217, s[80:81]
    v_cndmask_b32 v249, v217, v3, s[80:81]
    v_cmp_le_i32 vcc, 18, v2
    v_cmp_le_i32 s[80:81], 19, v2
    v_mov_b32 v218, 0
    v_mov_b32 v219, 0
    v_cndmask_b32 v234, v3, v218, vcc
    v_cndmask_b32 v250, v218, v3, vcc
    v_cndmask_b32 v235, v3, v219, s[80:81]
    v_cndmask_b32 v251, v219, v3, s[80:81]
    v_cmp_le_i32 vcc, 24, v2
    v_cmp_le_i32 s[80:81], 25, v2
    v_mov_b32 v220, 0
    v_mov_b32 v221, 0
    v_cndmask_b32 v236, v3, v220, vcc
    v_cndmask_b32 v252, v220, v3, vcc
    v_cndmask_b32 v237, v3, v221, s[80:81]
    v_cndmask_b32 v253, v221, v3, s[80:81]
    v_cmp_le_i32 vcc, 26, v2
    v_cmp_le_i32 s[80:81], 27, v2
    v_mov_b32 v222, 0
    v_mov_b32 v223, 0
    v_cndmask_b32 v238, v3, v222, vcc
    v_cndmask_b32 v254, v222, v3, vcc
    v_cndmask_b32 v239, v3, v223, s[80:81]
    v_cndmask_b32 v255, v223, v3, s[80:81]
    v_mov_b32 v4, 0xf149f2ca
    v_mov_b32 v59, 0xf149f2ca
    ds_read_b128 v[24:27], v197 offset:4096
    ds_read_b128 v[32:35], v198 offset:4096
    s_waitcnt lgkmcnt(0)
    v_mfma_f32_32x32x16_bf16 v[64:79], v[24:27], v[16:19], v[224:239]
    v_mfma_f32_32x32x16_bf16 v[64:79], v[32:35], v[20:23], v[64:79]
    s_nop 11
    v_max3_f32 v4, v4, v64, v65
    v_max3_f32 v4, v4, v66, v67
    v_max3_f32 v4, v4, v68, v69
    v_max3_f32 v4, v4, v70, v71
    v_max3_f32 v4, v4, v72, v73
    v_max3_f32 v4, v4, v74, v75
    v_max3_f32 v4, v4, v76, v77
    v_max3_f32 v4, v4, v78, v79
    s_cmp_lg_u32 s77, 1
    s_cbranch_scc1 L_hook_46
    s_nop 7
    v_mov_b32 v208, v59
    v_mov_b32 v240, v59
    v_mov_b32 v209, v59
    v_mov_b32 v241, v59
    v_mov_b32 v210, v59
    v_mov_b32 v242, v59
    v_mov_b32 v211, v59
    v_mov_b32 v243, v59
    v_mov_b32 v212, v59
    v_mov_b32 v244, v59
    v_mov_b32 v213, v59
    v_mov_b32 v245, v59
    v_mov_b32 v214, v59
    v_mov_b32 v246, v59
    v_mov_b32 v215, v59
    v_mov_b32 v247, v59
    v_mov_b32 v216, v59
    v_mov_b32 v248, v59
    v_mov_b32 v217, v59
    v_mov_b32 v249, v59
    v_mov_b32 v218, v59
    v_mov_b32 v250, v59
    v_mov_b32 v219, v59
    v_mov_b32 v251, v59
    v_mov_b32 v220, v59
    v_mov_b32 v252, v59
    v_mov_b32 v221, v59
    v_mov_b32 v253, v59
    v_mov_b32 v222, v59
    v_mov_b32 v254, v59
    v_mov_b32 v223, v59
    v_mov_b32 v255, v59
    s_nop 1
L_hook_46:
    ds_read_b128 v[28:31], v197 offset:3584
    s_waitcnt lgkmcnt(0)
    v_mfma_f32_32x32x16_bf16 v[80:95], v[28:31], v[16:19], v[208:223]
    v_mfma_f32_32x32x16_bf16 v[80:95], v[32:35], v[60:63], v[80:95]
    s_nop 11
    v_max3_f32 v4, v4, v80, v81
    v_max3_f32 v4, v4, v82, v83
    v_max3_f32 v4, v4, v84, v85
    v_max3_f32 v4, v4, v86, v87
    v_max3_f32 v4, v4, v88, v89
    v_max3_f32 v4, v4, v90, v91
    v_max3_f32 v4, v4, v92, v93
    v_max3_f32 v4, v4, v94, v95
    s_cmp_lg_u32 s77, 2
    s_cbranch_scc1 L_hook_47
    s_nop 7
    v_mov_b32 v208, v59
    v_mov_b32 v240, v59
    v_mov_b32 v209, v59
    v_mov_b32 v241, v59
    v_mov_b32 v210, v59
    v_mov_b32 v242, v59
    v_mov_b32 v211, v59
    v_mov_b32 v243, v59
    v_mov_b32 v212, v59
    v_mov_b32 v244, v59
    v_mov_b32 v213, v59
    v_mov_b32 v245, v59
    v_mov_b32 v214, v59
    v_mov_b32 v246, v59
    v_mov_b32 v215, v59
    v_mov_b32 v247, v59
    v_mov_b32 v216, v59
    v_mov_b32 v248, v59
    v_mov_b32 v217, v59
    v_mov_b32 v249, v59
    v_mov_b32 v218, v59
    v_mov_b32 v250, v59
    v_mov_b32 v219, v59
    v_mov_b32 v251, v59
    v_mov_b32 v220, v59
    v_mov_b32 v252, v59
    v_mov_b32 v221, v59
    v_mov_b32 v253, v59
    v_mov_b32 v222, v59
    v_mov_b32 v254, v59
    v_mov_b32 v223, v59
    v_mov_b32 v255, v59
    s_nop 1
L_hook_47:
    ds_read_b128 v[24:27], v197 offset:3072
    ds_read_b128 v[36:39], v198 offset:3072
    s_waitcnt lgkmcnt(0)
    v_mfma_f32_32x32x16_bf16 v[64:79], v[24:27], v[16:19], v[208:223]
    v_mfma_f32_32x32x16_bf16 v[64:79], v[36:39], v[20:23], v[64:79]
    s_nop 11
    v_max3_f32 v4, v4, v64, v65
    v_max3_f32 v4, v4, v66, v67
    v_max3_f32 v4, v4, v68, v69
    v_max3_f32 v4, v4, v70, v71
    v_max3_f32 v4, v4, v72, v73
    v_max3_f32 v4, v4, v74, v75
    v_max3_f32 v4, v4, v76, v77
    v_max3_f32 v4, v4, v78, v79
    s_cmp_lg_u32 s77, 3
    s_cbranch_scc1 L_hook_48
    s_nop 7
    v_mov_b32 v208, v59
    v_mov_b32 v240, v59
    v_mov_b32 v209, v59
    v_mov_b32 v241, v59
    v_mov_b32 v210, v59
    v_mov_b32 v242, v59
    v_mov_b32 v211, v59
    v_mov_b32 v243, v59
    v_mov_b32 v212, v59
    v_mov_b32 v244, v59
    v_mov_b32 v213, v59
    v_mov_b32 v245, v59
    v_mov_b32 v214, v59
    v_mov_b32 v246, v59
    v_mov_b32 v215, v59
    v_mov_b32 v247, v59
    v_mov_b32 v216, v59
    v_mov_b32 v248, v59
    v_mov_b32 v217, v59
    v_mov_b32 v249, v59
    v_mov_b32 v218, v59
    v_mov_b32 v250, v59
    v_mov_b32 v219, v59
    v_mov_b32 v251, v59
    v_mov_b32 v220, v59
    v_mov_b32 v252, v59
    v_mov_b32 v221, v59
    v_mov_b32 v253, v59
    v_mov_b32 v222, v59
    v_mov_b32 v254, v59
    v_mov_b32 v223, v59
    v_mov_b32 v255, v59
    s_nop 1
L_hook_48:
    ds_read_b128 v[28:31], v197 offset:2560
    s_waitcnt lgkmcnt(0)
    v_mfma_f32_32x32x16_bf16 v[80:95], v[28:31], v[16:19], v[208:223]
    v_mfma_f32_32x32x16_bf16 v[80:95], v[36:39], v[60:63], v[80:95]
    s_nop 11
    v_max3_f32 v4, v4, v80, v81
    v_max3_f32 v4, v4, v82, v83
    v_max3_f32 v4, v4, v84, v85
    v_max3_f32 v4, v4, v86, v87
    v_max3_f32 v4, v4, v88, v89
    v_max3_f32 v4, v4, v90, v91
    v_max3_f32 v4, v4, v92, v93
    v_max3_f32 v4, v4, v94, v95
    s_cmp_lg_u32 s77, 4
    s_cbranch_scc1 L_hook_49
    s_nop 7
    v_mov_b32 v208, v59
    v_mov_b32 v240, v59
    v_mov_b32 v209, v59
    v_mov_b32 v241, v59
    v_mov_b32 v210, v59
    v_mov_b32 v242, v59
    v_mov_b32 v211, v59
    v_mov_b32 v243, v59
    v_mov_b32 v212, v59
    v_mov_b32 v244, v59
    v_mov_b32 v213, v59
    v_mov_b32 v245, v59
    v_mov_b32 v214, v59
    v_mov_b32 v246, v59
    v_mov_b32 v215, v59
    v_mov_b32 v247, v59
    v_mov_b32 v216, v59
    v_mov_b32 v248, v59
    v_mov_b32 v217, v59
    v_mov_b32 v249, v59
    v_mov_b32 v218, v59
    v_mov_b32 v250, v59
    v_mov_b32 v219, v59
    v_mov_b32 v251, v59
    v_mov_b32 v220, v59
    v_mov_b32 v252, v59
    v_mov_b32 v221, v59
    v_mov_b32 v253, v59
    v_mov_b32 v222, v59
    v_mov_b32 v254, v59
    v_mov_b32 v223, v59
    v_mov_b32 v255, v59
    s_nop 1
L_hook_49:
    ds_read_b128 v[24:27], v197 offset:2048
    ds_read_b128 v[32:35], v198 offset:2048
    s_waitcnt lgkmcnt(0)
    v_mfma_f32_32x32x16_bf16 v[64:79], v[24:27], v[16:19], v[208:223]
    v_mfma_f32_32x32x16_bf16 v[64:79], v[32:35], v[20:23], v[64:79]
    s_nop 11
    v_max3_f32 v4, v4, v64, v65
    v_max3_f32 v4, v4, v66, v67
    v_max3_f32 v4, v4, v68, v69
    v_max3_f32 v4, v4, v70, v71
    v_max3_f32 v4, v4, v72, v73
    v_max3_f32 v4, v4, v74, v75
    v_max3_f32 v4, v4, v76, v77
    v_max3_f32 v4, v4, v78, v79
    s_cmp_lg_u32 s77, 5
    s_cbranch_scc1 L_hook_50
    s_nop 7
    v_mov_b32 v208, v59
    v_mov_b32 v240, v59
    v_mov_b32 v209, v59
    v_mov_b32 v241, v59
    v_mov_b32 v210, v59
    v_mov_b32 v242, v59
    v_mov_b32 v211, v59
    v_mov_b32 v243, v59
    v_mov_b32 v212, v59
    v_mov_b32 v244, v59
    v_mov_b32 v213, v59
    v_mov_b32 v245, v59
    v_mov_b32 v214, v59
    v_mov_b32 v246, v59
    v_mov_b32 v215, v59
    v_mov_b32 v247, v59
    v_mov_b32 v216, v59
    v_mov_b32 v248, v59
    v_mov_b32 v217, v59
    v_mov_b32 v249, v59
    v_mov_b32 v218, v59
    v_mov_b32 v250, v59
    v_mov_b32 v219, v59
    v_mov_b32 v251, v59
    v_mov_b32 v220, v59
    v_mov_b32 v252, v59
    v_mov_b32 v221, v59
    v_mov_b32 v253, v59
    v_mov_b32 v222, v59
    v_mov_b32 v254, v59
    v_mov_b32 v223, v59
    v_mov_b32 v255, v59
    s_nop 1
L_hook_50:
    ds_read_b128 v[28:31], v197 offset:1536
    s_waitcnt lgkmcnt(0)
    v_mfma_f32_32x32x16_bf16 v[80:95], v[28:31], v[16:19], v[208:223]
    v_mfma_f32_32x32x16_bf16 v[80:95], v[32:35], v[60:63], v[80:95]
    s_nop 11
    v_max3_f32 v4, v4, v80, v81
    v_max3_f32 v4, v4, v82, v83
    v_max3_f32 v4, v4, v84, v85
    v_max3_f32 v4, v4, v86, v87
    v_max3_f32 v4, v4, v88, v89
    v_max3_f32 v4, v4, v90, v91
    v_max3_f32 v4, v4, v92, v93
    v_max3_f32 v4, v4, v94, v95
    s_cmp_lg_u32 s77, 6
    s_cbranch_scc1 L_hook_51
    s_nop 7
    v_mov_b32 v208, v59
    v_mov_b32 v240, v59
    v_mov_b32 v209, v59
    v_mov_b32 v241, v59
    v_mov_b32 v210, v59
    v_mov_b32 v242, v59
    v_mov_b32 v211, v59
    v_mov_b32 v243, v59
    v_mov_b32 v212, v59
    v_mov_b32 v244, v59
    v_mov_b32 v213, v59
    v_mov_b32 v245, v59
    v_mov_b32 v214, v59
    v_mov_b32 v246, v59
    v_mov_b32 v215, v59
    v_mov_b32 v247, v59
    v_mov_b32 v216, v59
    v_mov_b32 v248, v59
    v_mov_b32 v217, v59
    v_mov_b32 v249, v59
    v_mov_b32 v218, v59
    v_mov_b32 v250, v59
    v_mov_b32 v219, v59
    v_mov_b32 v251, v59
    v_mov_b32 v220, v59
    v_mov_b32 v252, v59
    v_mov_b32 v221, v59
    v_mov_b32 v253, v59
    v_mov_b32 v222, v59
    v_mov_b32 v254, v59
    v_mov_b32 v223, v59
    v_mov_b32 v255, v59
    s_nop 1
L_hook_51:
    ds_read_b128 v[24:27], v197 offset:1024
    ds_read_b128 v[36:39], v198 offset:1024
    s_waitcnt lgkmcnt(0)
    v_mfma_f32_32x32x16_bf16 v[64:79], v[24:27], v[16:19], v[208:223]
    v_mfma_f32_32x32x16_bf16 v[64:79], v[36:39], v[20:23], v[64:79]
    s_nop 11
    v_max3_f32 v4, v4, v64, v65
    v_max3_f32 v4, v4, v66, v67
    v_max3_f32 v4, v4, v68, v69
    v_max3_f32 v4, v4, v70, v71
    v_max3_f32 v4, v4, v72, v73
    v_max3_f32 v4, v4, v74, v75
    v_max3_f32 v4, v4, v76, v77
    v_max3_f32 v4, v4, v78, v79
    s_cmp_lg_u32 s77, 7
    s_cbranch_scc1 L_hook_52
    s_nop 7
    v_mov_b32 v208, v59
    v_mov_b32 v240, v59
    v_mov_b32 v209, v59
    v_mov_b32 v241, v59
    v_mov_b32 v210, v59
    v_mov_b32 v242, v59
    v_mov_b32 v211, v59
    v_mov_b32 v243, v59
    v_mov_b32 v212, v59
    v_mov_b32 v244, v59
    v_mov_b32 v213, v59
    v_mov_b32 v245, v59
    v_mov_b32 v214, v59
    v_mov_b32 v246, v59
    v_mov_b32 v215, v59
    v_mov_b32 v247, v59
    v_mov_b32 v216, v59
    v_mov_b32 v248, v59
    v_mov_b32 v217, v59
    v_mov_b32 v249, v59
    v_mov_b32 v218, v59
    v_mov_b32 v250, v59
    v_mov_b32 v219, v59
    v_mov_b32 v251, v59
    v_mov_b32 v220, v59
    v_mov_b32 v252, v59
    v_mov_b32 v221, v59
    v_mov_b32 v253, v59
    v_mov_b32 v222, v59
    v_mov_b32 v254, v59
    v_mov_b32 v223, v59
    v_mov_b32 v255, v59
    s_nop 1
L_hook_52:
    ds_read_b128 v[28:31], v197 offset:512
    s_waitcnt lgkmcnt(0)
    v_mfma_f32_32x32x16_bf16 v[80:95], v[28:31], v[16:19], v[208:223]
    v_mfma_f32_32x32x16_bf16 v[80:95], v[36:39], v[60:63], v[80:95]
    s_nop 11
    v_max3_f32 v4, v4, v80, v81
    v_max3_f32 v4, v4, v82, v83
    v_max3_f32 v4, v4, v84, v85
    v_max3_f32 v4, v4, v86, v87
    v_max3_f32 v4, v4, v88, v89
    v_max3_f32 v4, v4, v90, v91
    v_max3_f32 v4, v4, v92, v93
    v_max3_f32 v4, v4, v94, v95
    s_cmp_lg_u32 s77, 8
    s_cbranch_scc1 L_hook_53
    s_nop 7
    v_mov_b32 v208, v59
    v_mov_b32 v240, v59
    v_mov_b32 v209, v59
    v_mov_b32 v241, v59
    v_mov_b32 v210, v59
    v_mov_b32 v242, v59
    v_mov_b32 v211, v59
    v_mov_b32 v243, v59
    v_mov_b32 v212, v59
    v_mov_b32 v244, v59
    v_mov_b32 v213, v59
    v_mov_b32 v245, v59
    v_mov_b32 v214, v59
    v_mov_b32 v246, v59
    v_mov_b32 v215, v59
    v_mov_b32 v247, v59
    v_mov_b32 v216, v59
    v_mov_b32 v248, v59
    v_mov_b32 v217, v59
    v_mov_b32 v249, v59
    v_mov_b32 v218, v59
    v_mov_b32 v250, v59
    v_mov_b32 v219, v59
    v_mov_b32 v251, v59
    v_mov_b32 v220, v59
    v_mov_b32 v252, v59
    v_mov_b32 v221, v59
    v_mov_b32 v253, v59
    v_mov_b32 v222, v59
    v_mov_b32 v254, v59
    v_mov_b32 v223, v59
    v_mov_b32 v255, v59
    s_nop 1
L_hook_53:
    ds_read_b128 v[24:27], v197 offset:0
    ds_read_b128 v[32:35], v198 offset:0
    s_waitcnt lgkmcnt(0)
    v_mfma_f32_32x32x16_bf16 v[64:79], v[24:27], v[16:19], v[240:255]
    v_mfma_f32_32x32x16_bf16 v[64:79], v[32:35], v[20:23], v[64:79]
    s_nop 11
    v_max3_f32 v4, v4, v64, v65
    v_max3_f32 v4, v4, v66, v67
    v_max3_f32 v4, v4, v68, v69
    v_max3_f32 v4, v4, v70, v71
    v_max3_f32 v4, v4, v72, v73
    v_max3_f32 v4, v4, v74, v75
    v_max3_f32 v4, v4, v76, v77
    v_max3_f32 v4, v4, v78, v79
    v_mov_b32 v5, v4
    s_nop 1
    v_permlane32_swap_b32 v4, v5
    v_max_f32 v4, v4, v5
    v_sub_f32 v4, 0, v4
    v_and_b32 v2, 31, v1
    v_lshrrev_b32 v3, 5, v1
    v_lshlrev_b32 v3, 2, v3
    v_sub_u32 v2, v2, v3
    v_mov_b32 v3, 0xf149f2ca
    v_cmp_le_i32 vcc, 0, v2
    v_cmp_le_i32 s[80:81], 1, v2
    v_mov_b32 v208, v4
    v_mov_b32 v209, v4
    v_cndmask_b32 v224, v3, v208, vcc
    v_cndmask_b32 v240, v208, v3, vcc
    v_cndmask_b32 v225, v3, v209, s[80:81]
    v_cndmask_b32 v241, v209, v3, s[80:81]
    v_cmp_le_i32 vcc, 2, v2
    v_cmp_le_i32 s[80:81], 3, v2
    v_mov_b32 v210, v4
    v_mov_b32 v211, v4
    v_cndmask_b32 v226, v3, v210, vcc
    v_cndmask_b32 v242, v210, v3, vcc
    v_cndmask_b32 v227, v3, v211, s[80:81]
    v_cndmask_b32 v243, v211, v3, s[80:81]
    v_cmp_le_i32 vcc, 8, v2
    v_cmp_le_i32 s[80:81], 9, v2
    v_mov_b32 v212, v4
    v_mov_b32 v213, v4
    v_cndmask_b32 v228, v3, v212, vcc
    v_cndmask_b32 v244, v212, v3, vcc
    v_cndmask_b32 v229, v3, v213, s[80:81]
    v_cndmask_b32 v245, v213, v3, s[80:81]
    v_cmp_le_i32 vcc, 10, v2
    v_cmp_le_i32 s[80:81], 11, v2
    v_mov_b32 v214, v4
    v_mov_b32 v215, v4
    v_cndmask_b32 v230, v3, v214, vcc
    v_cndmask_b32 v246, v214, v3, vcc
    v_cndmask_b32 v231, v3, v215, s[80:81]
    v_cndmask_b32 v247, v215, v3, s[80:81]
    v_cmp_le_i32 vcc, 16, v2
    v_cmp_le_i32 s[80:81], 17, v2
    v_mov_b32 v216, v4
    v_mov_b32 v217, v4
    v_cndmask_b32 v232, v3, v216, vcc
    v_cndmask_b32 v248, v216, v3, vcc
    v_cndmask_b32 v233, v3, v217, s[80:81]
    v_cndmask_b32 v249, v217, v3, s[80:81]
    v_cmp_le_i32 vcc, 18, v2
    v_cmp_le_i32 s[80:81], 19, v2
    v_mov_b32 v218, v4
    v_mov_b32 v219, v4
    v_cndmask_b32 v234, v3, v218, vcc
    v_cndmask_b32 v250, v218, v3, vcc
    v_cndmask_b32 v235, v3, v219, s[80:81]
    v_cndmask_b32 v251, v219, v3, s[80:81]
    v_cmp_le_i32 vcc, 24, v2
    v_cmp_le_i32 s[80:81], 25, v2
    v_mov_b32 v220, v4
    v_mov_b32 v221, v4
    v_cndmask_b32 v236, v3, v220, vcc
    v_cndmask_b32 v252, v220, v3, vcc
    v_cndmask_b32 v237, v3, v221, s[80:81]
    v_cndmask_b32 v253, v221, v3, s[80:81]
    v_cmp_le_i32 vcc, 26, v2
    v_cmp_le_i32 s[80:81], 27, v2
    v_mov_b32 v222, v4
    v_mov_b32 v223, v4
    v_cndmask_b32 v238, v3, v222, vcc
    v_cndmask_b32 v254, v222, v3, vcc
    v_cndmask_b32 v239, v3, v223, s[80:81]
    v_cndmask_b32 v255, v223, v3, s[80:81]
    ds_read_b128 v[24:27], v197 offset:4096
    ds_read_b128 v[32:35], v198 offset:4096
    ds_read_b128 v[28:31], v197 offset:3584
    s_branch L_a2_gen
L_a2_gen:
    v_mov_b32 v59, 0xf149f2ca
    s_waitcnt lgkmcnt(1)
    v_mfma_f32_32x32x16_bf16 v[64:79], v[24:27], v[16:19], v[224:239]
    v_mfma_f32_32x32x16_bf16 v[64:79], v[32:35], v[20:23], v[64:79]
    ds_read_b64_tr_b16 v[40:41], v190 offset:512
    ds_read_b64_tr_b16 v[42:43], v190 offset:640
    ds_read_b64_tr_b16 v[44:45], v190 offset:768
    ds_read_b64_tr_b16 v[46:47], v190 offset:896
    ds_read_b128 v[24:27], v197 offset:3072
    ds_read_b128 v[36:39], v198 offset:3072
    s_nop 5
    v_exp_f32 v64, v64
    v_exp_f32 v65, v65
    v_exp_f32 v66, v66
    v_exp_f32 v67, v67
    s_cmp_lg_u32 s77, 1
    s_cbranch_scc1 L_hook_54
    s_nop 7
    v_mov_b32 v208, v59
    v_mov_b32 v240, v59
    v_mov_b32 v209, v59
    v_mov_b32 v241, v59
    v_mov_b32 v210, v59
    v_mov_b32 v242, v59
    v_mov_b32 v211, v59
    v_mov_b32 v243, v59
    v_mov_b32 v212, v59
    v_mov_b32 v244, v59
    v_mov_b32 v213, v59
    v_mov_b32 v245, v59
    v_mov_b32 v214, v59
    v_mov_b32 v246, v59
    v_mov_b32 v215, v59
    v_mov_b32 v247, v59
    v_mov_b32 v216, v59
    v_mov_b32 v248, v59
    v_mov_b32 v217, v59
    v_mov_b32 v249, v59
    v_mov_b32 v218, v59
    v_mov_b32 v250, v59
    v_mov_b32 v219, v59
    v_mov_b32 v251, v59
    v_mov_b32 v220, v59
    v_mov_b32 v252, v59
    v_mov_b32 v221, v59
    v_mov_b32 v253, v59
    v_mov_b32 v222, v59
    v_mov_b32 v254, v59
    v_mov_b32 v223, v59
    v_mov_b32 v255, v59
    s_nop 1
L_hook_54:
    s_waitcnt lgkmcnt(6)
    v_mfma_f32_32x32x16_bf16 v[80:95], v[28:31], v[16:19], v[208:223]
    v_exp_f32 v68, v68
    v_exp_f32 v69, v69
    v_cvt_pk_bf16_f32 v96, v64, v65
    v_cvt_pk_bf16_f32 v97, v66, v67
    v_exp_f32 v70, v70
    v_exp_f32 v71, v71
    v_mfma_f32_32x32x16_bf16 v[80:95], v[32:35], v[60:63], v[80:95]
    v_exp_f32 v72, v72
    v_exp_f32 v73, v73
    v_cvt_pk_bf16_f32 v98, v68, v69
    v_cvt_pk_bf16_f32 v99, v70, v71
    v_exp_f32 v74, v74
    v_exp_f32 v75, v75
    v_exp_f32 v76, v76
    v_exp_f32 v77, v77
    v_cvt_pk_bf16_f32 v100, v72, v73
    v_cvt_pk_bf16_f32 v101, v74, v75
    v_exp_f32 v78, v78
    v_exp_f32 v79, v79
    s_waitcnt lgkmcnt(0)
    v_mfma_f32_32x32x16_bf16 v[112:127], v[40:43], v[96:99], 0
    ds_read_b64_tr_b16 v[48:49], v190 offset:0
    ds_read_b64_tr_b16 v[50:51], v190 offset:128
    ds_read_b64_tr_b16 v[52:53], v190 offset:256
    ds_read_b64_tr_b16 v[54:55], v190 offset:384
    ds_read_b128 v[28:31], v197 offset:2560
    v_exp_f32 v80, v80
    v_exp_f32 v81, v81
    v_cvt_pk_bf16_f32 v102, v76, v77
    v_cvt_pk_bf16_f32 v103, v78, v79
    v_exp_f32 v82, v82
    v_exp_f32 v83, v83
    s_cmp_lg_u32 s77, 2
    s_cbranch_scc1 L_hook_55
    s_nop 7
    v_mov_b32 v208, v59
    v_mov_b32 v240, v59
    v_mov_b32 v209, v59
    v_mov_b32 v241, v59
    v_mov_b32 v210, v59
    v_mov_b32 v242, v59
    v_mov_b32 v211, v59
    v_mov_b32 v243, v59
    v_mov_b32 v212, v59
    v_mov_b32 v244, v59
    v_mov_b32 v213, v59
    v_mov_b32 v245, v59
    v_mov_b32 v214, v59
    v_mov_b32 v246, v59
    v_mov_b32 v215, v59
    v_mov_b32 v247, v59
    v_mov_b32 v216, v59
    v_mov_b32 v248, v59
    v_mov_b32 v217, v59
    v_mov_b32 v249, v59
    v_mov_b32 v218, v59
    v_mov_b32 v250, v59
    v_mov_b32 v219, v59
    v_mov_b32 v251, v59
    v_mov_b32 v220, v59
    v_mov_b32 v252, v59
    v_mov_b32 v221, v59
    v_mov_b32 v253, v59
    v_mov_b32 v222, v59
    v_mov_b32 v254, v59
    v_mov_b32 v223, v59
    v_mov_b32 v255, v59
    s_nop 1
L_hook_55:
    v_mfma_f32_32x32x16_bf16 v[64:79], v[24:27], v[16:19], v[208:223]
    v_exp_f32 v84, v84
    v_exp_f32 v85, v85
    v_cvt_pk_bf16_f32 v104, v80, v81
    v_cvt_pk_bf16_f32 v105, v82, v83
    v_exp_f32 v86, v86
    v_exp_f32 v87, v87
    v_mfma_f32_32x32x16_bf16 v[64:79], v[36:39], v[20:23], v[64:79]
    v_exp_f32 v88, v88
    v_exp_f32 v89, v89
    v_cvt_pk_bf16_f32 v106, v84, v85
    v_cvt_pk_bf16_f32 v107, v86, v87
    v_exp_f32 v90, v90
    v_exp_f32 v91, v91
    v_mfma_f32_32x32x16_bf16 v[112:127], v[44:47], v[100:103], v[112:127]
    v_exp_f32 v92, v92
    v_exp_f32 v93, v93
    v_cvt_pk_bf16_f32 v108, v88, v89
    v_cvt_pk_bf16_f32 v109, v90, v91
    v_exp_f32 v94, v94
    v_exp_f32 v95, v95
    s_waitcnt lgkmcnt(0)
    v_mfma_f32_32x32x16_bf16 v[112:127], v[48:51], v[104:107], v[112:127]
    ds_read_b64_tr_b16 v[40:41], v191 offset:512
    ds_read_b64_tr_b16 v[42:43], v191 offset:640
    ds_read_b64_tr_b16 v[44:45], v191 offset:768
    ds_read_b64_tr_b16 v[46:47], v191 offset:896
    ds_read_b128 v[24:27], v197 offset:2048
    ds_read_b128 v[32:35], v198 offset:2048
    v_exp_f32 v64, v64
    v_exp_f32 v65, v65
    v_cvt_pk_bf16_f32 v110, v92, v93
    v_cvt_pk_bf16_f32 v111, v94, v95
    v_exp_f32 v66, v66
    v_exp_f32 v67, v67
    s_cmp_lg_u32 s77, 3
    s_cbranch_scc1 L_hook_56
    s_nop 7
    v_mov_b32 v208, v59
    v_mov_b32 v240, v59
    v_mov_b32 v209, v59
    v_mov_b32 v241, v59
    v_mov_b32 v210, v59
    v_mov_b32 v242, v59
    v_mov_b32 v211, v59
    v_mov_b32 v243, v59
    v_mov_b32 v212, v59
    v_mov_b32 v244, v59
    v_mov_b32 v213, v59
    v_mov_b32 v245, v59
    v_mov_b32 v214, v59
    v_mov_b32 v246, v59
    v_mov_b32 v215, v59
    v_mov_b32 v247, v59
    v_mov_b32 v216, v59
    v_mov_b32 v248, v59
    v_mov_b32 v217, v59
    v_mov_b32 v249, v59
    v_mov_b32 v218, v59
    v_mov_b32 v250, v59
    v_mov_b32 v219, v59
    v_mov_b32 v251, v59
    v_mov_b32 v220, v59
    v_mov_b32 v252, v59
    v_mov_b32 v221, v59
    v_mov_b32 v253, v59
    v_mov_b32 v222, v59
    v_mov_b32 v254, v59
    v_mov_b32 v223, v59
    v_mov_b32 v255, v59
    s_nop 1
L_hook_56:
    v_mfma_f32_32x32x16_bf16 v[80:95], v[28:31], v[16:19], v[208:223]
    v_exp_f32 v68, v68
    v_exp_f32 v69, v69
    v_cvt_pk_bf16_f32 v96, v64, v65
    v_cvt_pk_bf16_f32 v97, v66, v67
    v_exp_f32 v70, v70
    v_exp_f32 v71, v71
    v_mfma_f32_32x32x16_bf16 v[80:95], v[36:39], v[60:63], v[80:95]
    v_exp_f32 v72, v72
    v_exp_f32 v73, v73
    v_cvt_pk_bf16_f32 v98, v68, v69
    v_cvt_pk_bf16_f32 v99, v70, v71
    v_exp_f32 v74, v74
    v_exp_f32 v75, v75
    v_mfma_f32_32x32x16_bf16 v[112:127], v[52:55], v[108:111], v[112:127]
    v_exp_f32 v76, v76
    v_exp_f32 v77, v77
    v_cvt_pk_bf16_f32 v100, v72, v73
    v_cvt_pk_bf16_f32 v101, v74, v75
    v_exp_f32 v78, v78
    v_exp_f32 v79, v79
    s_waitcnt lgkmcnt(0)
    v_mfma_f32_32x32x16_bf16 v[112:127], v[40:43], v[96:99], v[112:127]
    ds_read_b64_tr_b16 v[48:49], v191 offset:0
    ds_read_b64_tr_b16 v[50:51], v191 offset:128
    ds_read_b64_tr_b16 v[52:53], v191 offset:256
    ds_read_b64_tr_b16 v[54:55], v191 offset:384
    ds_read_b128 v[28:31], v197 offset:1536
    v_exp_f32 v80, v80
    v_exp_f32 v81, v81
    v_cvt_pk_bf16_f32 v102, v76, v77
    v_cvt_pk_bf16_f32 v103, v78, v79
    v_exp_f32 v82, v82
    v_exp_f32 v83, v83
    s_cmp_lg_u32 s77, 4
    s_cbranch_scc1 L_hook_57
    s_nop 7
    v_mov_b32 v208, v59
    v_mov_b32 v240, v59
    v_mov_b32 v209, v59
    v_mov_b32 v241, v59
    v_mov_b32 v210, v59
    v_mov_b32 v242, v59
    v_mov_b32 v211, v59
    v_mov_b32 v243, v59
    v_mov_b32 v212, v59
    v_mov_b32 v244, v59
    v_mov_b32 v213, v59
    v_mov_b32 v245, v59
    v_mov_b32 v214, v59
    v_mov_b32 v246, v59
    v_mov_b32 v215, v59
    v_mov_b32 v247, v59
    v_mov_b32 v216, v59
    v_mov_b32 v248, v59
    v_mov_b32 v217, v59
    v_mov_b32 v249, v59
    v_mov_b32 v218, v59
    v_mov_b32 v250, v59
    v_mov_b32 v219, v59
    v_mov_b32 v251, v59
    v_mov_b32 v220, v59
    v_mov_b32 v252, v59
    v_mov_b32 v221, v59
    v_mov_b32 v253, v59
    v_mov_b32 v222, v59
    v_mov_b32 v254, v59
    v_mov_b32 v223, v59
    v_mov_b32 v255, v59
    s_nop 1
L_hook_57:
    v_mfma_f32_32x32x16_bf16 v[64:79], v[24:27], v[16:19], v[208:223]
    v_exp_f32 v84, v84
    v_exp_f32 v85, v85
    v_cvt_pk_bf16_f32 v104, v80, v81
    v_cvt_pk_bf16_f32 v105, v82, v83
    v_exp_f32 v86, v86
    v_exp_f32 v87, v87
    v_mfma_f32_32x32x16_bf16 v[64:79], v[32:35], v[20:23], v[64:79]
    v_exp_f32 v88, v88
    v_exp_f32 v89, v89
    v_cvt_pk_bf16_f32 v106, v84, v85
    v_cvt_pk_bf16_f32 v107, v86, v87
    v_exp_f32 v90, v90
    v_exp_f32 v91, v91
    v_mfma_f32_32x32x16_bf16 v[112:127], v[44:47], v[100:103], v[112:127]
    v_exp_f32 v92, v92
    v_exp_f32 v93, v93
    v_cvt_pk_bf16_f32 v108, v88, v89
    v_cvt_pk_bf16_f32 v109, v90, v91
    v_exp_f32 v94, v94
    v_exp_f32 v95, v95
    s_waitcnt lgkmcnt(0)
    v_mfma_f32_32x32x16_bf16 v[112:127], v[48:51], v[104:107], v[112:127]
    ds_read_b64_tr_b16 v[40:41], v192 offset:512
    ds_read_b64_tr_b16 v[42:43], v192 offset:640
    ds_read_b64_tr_b16 v[44:45], v192 offset:768
    ds_read_b64_tr_b16 v[46:47], v192 offset:896
    ds_read_b128 v[24:27], v197 offset:1024
    ds_read_b128 v[36:39], v198 offset:1024
    v_exp_f32 v64, v64
    v_exp_f32 v65, v65
    v_cvt_pk_bf16_f32 v110, v92, v93
    v_cvt_pk_bf16_f32 v111, v94, v95
    v_exp_f32 v66, v66
    v_exp_f32 v67, v67
    s_cmp_lg_u32 s77, 5
    s_cbranch_scc1 L_hook_58
    s_nop 7
    v_mov_b32 v208, v59
    v_mov_b32 v240, v59
    v_mov_b32 v209, v59
    v_mov_b32 v241, v59
    v_mov_b32 v210, v59
    v_mov_b32 v242, v59
    v_mov_b32 v211, v59
    v_mov_b32 v243, v59
    v_mov_b32 v212, v59
    v_mov_b32 v244, v59
    v_mov_b32 v213, v59
    v_mov_b32 v245, v59
    v_mov_b32 v214, v59
    v_mov_b32 v246, v59
    v_mov_b32 v215, v59
    v_mov_b32 v247, v59
    v_mov_b32 v216, v59
    v_mov_b32 v248, v59
    v_mov_b32 v217, v59
    v_mov_b32 v249, v59
    v_mov_b32 v218, v59
    v_mov_b32 v250, v59
    v_mov_b32 v219, v59
    v_mov_b32 v251, v59
    v_mov_b32 v220, v59
    v_mov_b32 v252, v59
    v_mov_b32 v221, v59
    v_mov_b32 v253, v59
    v_mov_b32 v222, v59
    v_mov_b32 v254, v59
    v_mov_b32 v223, v59
    v_mov_b32 v255, v59
    s_nop 1
L_hook_58:
    v_mfma_f32_32x32x16_bf16 v[80:95], v[28:31], v[16:19], v[208:223]
    v_exp_f32 v68, v68
    v_exp_f32 v69, v69
    v_cvt_pk_bf16_f32 v96, v64, v65
    v_cvt_pk_bf16_f32 v97, v66, v67
    v_exp_f32 v70, v70
    v_exp_f32 v71, v71
    v_mfma_f32_32x32x16_bf16 v[80:95], v[32:35], v[60:63], v[80:95]
    v_exp_f32 v72, v72
    v_exp_f32 v73, v73
    v_cvt_pk_bf16_f32 v98, v68, v69
    v_cvt_pk_bf16_f32 v99, v70, v71
    v_exp_f32 v74, v74
    v_exp_f32 v75, v75
    v_mfma_f32_32x32x16_bf16 v[112:127], v[52:55], v[108:111], v[112:127]
    v_exp_f32 v76, v76
    v_exp_f32 v77, v77
    v_cvt_pk_bf16_f32 v100, v72, v73
    v_cvt_pk_bf16_f32 v101, v74, v75
    v_exp_f32 v78, v78
    v_exp_f32 v79, v79
    s_setprio 0
    s_waitcnt lgkmcnt(0)
    v_mfma_f32_32x32x16_bf16 v[112:127], v[40:43], v[96:99], v[112:127]
    ds_read_b64_tr_b16 v[48:49], v192 offset:0
    ds_read_b64_tr_b16 v[50:51], v192 offset:128
    ds_read_b64_tr_b16 v[52:53], v192 offset:256
    ds_read_b64_tr_b16 v[54:55], v192 offset:384
    ds_read_b128 v[28:31], v197 offset:512
    v_exp_f32 v80, v80
    v_exp_f32 v81, v81
    v_cvt_pk_bf16_f32 v102, v76, v77
    v_cvt_pk_bf16_f32 v103, v78, v79
    v_exp_f32 v82, v82
    v_exp_f32 v83, v83
    s_cmp_lg_u32 s77, 6
    s_cbranch_scc1 L_hook_59
    s_nop 7
    v_mov_b32 v208, v59
    v_mov_b32 v240, v59
    v_mov_b32 v209, v59
    v_mov_b32 v241, v59
    v_mov_b32 v210, v59
    v_mov_b32 v242, v59
    v_mov_b32 v211, v59
    v_mov_b32 v243, v59
    v_mov_b32 v212, v59
    v_mov_b32 v244, v59
    v_mov_b32 v213, v59
    v_mov_b32 v245, v59
    v_mov_b32 v214, v59
    v_mov_b32 v246, v59
    v_mov_b32 v215, v59
    v_mov_b32 v247, v59
    v_mov_b32 v216, v59
    v_mov_b32 v248, v59
    v_mov_b32 v217, v59
    v_mov_b32 v249, v59
    v_mov_b32 v218, v59
    v_mov_b32 v250, v59
    v_mov_b32 v219, v59
    v_mov_b32 v251, v59
    v_mov_b32 v220, v59
    v_mov_b32 v252, v59
    v_mov_b32 v221, v59
    v_mov_b32 v253, v59
    v_mov_b32 v222, v59
    v_mov_b32 v254, v59
    v_mov_b32 v223, v59
    v_mov_b32 v255, v59
    s_nop 1
L_hook_59:
    v_mfma_f32_32x32x16_bf16 v[64:79], v[24:27], v[16:19], v[208:223]
    v_exp_f32 v84, v84
    v_exp_f32 v85, v85
    v_cvt_pk_bf16_f32 v104, v80, v81
    v_cvt_pk_bf16_f32 v105, v82, v83
    v_exp_f32 v86, v86
    v_exp_f32 v87, v87
    v_mfma_f32_32x32x16_bf16 v[64:79], v[36:39], v[20:23], v[64:79]
    v_exp_f32 v88, v88
    v_exp_f32 v89, v89
    v_cvt_pk_bf16_f32 v106, v84, v85
    v_cvt_pk_bf16_f32 v107, v86, v87
    v_exp_f32 v90, v90
    v_exp_f32 v91, v91
    v_mfma_f32_32x32x16_bf16 v[112:127], v[44:47], v[100:103], v[112:127]
    v_exp_f32 v92, v92
    v_exp_f32 v93, v93
    v_cvt_pk_bf16_f32 v108, v88, v89
    v_cvt_pk_bf16_f32 v109, v90, v91
    v_exp_f32 v94, v94
    v_exp_f32 v95, v95
    s_waitcnt lgkmcnt(0)
    v_mfma_f32_32x32x16_bf16 v[112:127], v[48:51], v[104:107], v[112:127]
    ds_read_b64_tr_b16 v[40:41], v193 offset:512
    ds_read_b64_tr_b16 v[42:43], v193 offset:640
    ds_read_b64_tr_b16 v[44:45], v193 offset:768
    ds_read_b64_tr_b16 v[46:47], v193 offset:896
    ds_read_b128 v[24:27], v197 offset:0
    ds_read_b128 v[32:35], v198 offset:0
    v_exp_f32 v64, v64
    v_exp_f32 v65, v65
    v_cvt_pk_bf16_f32 v110, v92, v93
    v_cvt_pk_bf16_f32 v111, v94, v95
    v_exp_f32 v66, v66
    v_exp_f32 v67, v67
    s_cmp_lg_u32 s77, 7
    s_cbranch_scc1 L_hook_60
    s_nop 7
    v_mov_b32 v208, v59
    v_mov_b32 v240, v59
    v_mov_b32 v209, v59
    v_mov_b32 v241, v59
    v_mov_b32 v210, v59
    v_mov_b32 v242, v59
    v_mov_b32 v211, v59
    v_mov_b32 v243, v59
    v_mov_b32 v212, v59
    v_mov_b32 v244, v59
    v_mov_b32 v213, v59
    v_mov_b32 v245, v59
    v_mov_b32 v214, v59
    v_mov_b32 v246, v59
    v_mov_b32 v215, v59
    v_mov_b32 v247, v59
    v_mov_b32 v216, v59
    v_mov_b32 v248, v59
    v_mov_b32 v217, v59
    v_mov_b32 v249, v59
    v_mov_b32 v218, v59
    v_mov_b32 v250, v59
    v_mov_b32 v219, v59
    v_mov_b32 v251, v59
    v_mov_b32 v220, v59
    v_mov_b32 v252, v59
    v_mov_b32 v221, v59
    v_mov_b32 v253, v59
    v_mov_b32 v222, v59
    v_mov_b32 v254, v59
    v_mov_b32 v223, v59
    v_mov_b32 v255, v59
    s_nop 1
L_hook_60:
    v_mfma_f32_32x32x16_bf16 v[80:95], v[28:31], v[16:19], v[208:223]
    v_exp_f32 v68, v68
    v_exp_f32 v69, v69
    v_cvt_pk_bf16_f32 v96, v64, v65
    v_cvt_pk_bf16_f32 v97, v66, v67
    v_exp_f32 v70, v70
    v_exp_f32 v71, v71
    v_mfma_f32_32x32x16_bf16 v[80:95], v[36:39], v[60:63], v[80:95]
    v_exp_f32 v72, v72
    v_exp_f32 v73, v73
    v_cvt_pk_bf16_f32 v98, v68, v69
    v_cvt_pk_bf16_f32 v99, v70, v71
    v_exp_f32 v74, v74
    v_exp_f32 v75, v75
    v_mfma_f32_32x32x16_bf16 v[112:127], v[52:55], v[108:111], v[112:127]
    v_exp_f32 v76, v76
    v_exp_f32 v77, v77
    v_cvt_pk_bf16_f32 v100, v72, v73
    v_cvt_pk_bf16_f32 v101, v74, v75
    v_exp_f32 v78, v78
    v_exp_f32 v79, v79
    s_waitcnt lgkmcnt(0)
    v_mfma_f32_32x32x16_bf16 v[112:127], v[40:43], v[96:99], v[112:127]
    ds_read_b64_tr_b16 v[48:49], v193 offset:0
    ds_read_b64_tr_b16 v[50:51], v193 offset:128
    ds_read_b64_tr_b16 v[52:53], v193 offset:256
    ds_read_b64_tr_b16 v[54:55], v193 offset:384
    v_exp_f32 v80, v80
    v_exp_f32 v81, v81
    v_cvt_pk_bf16_f32 v102, v76, v77
    v_cvt_pk_bf16_f32 v103, v78, v79
    v_exp_f32 v82, v82
    v_exp_f32 v83, v83
    s_cmp_lg_u32 s77, 8
    s_cbranch_scc1 L_hook_61
    s_nop 7
    v_mov_b32 v208, v59
    v_mov_b32 v240, v59
    v_mov_b32 v209, v59
    v_mov_b32 v241, v59
    v_mov_b32 v210, v59
    v_mov_b32 v242, v59
    v_mov_b32 v211, v59
    v_mov_b32 v243, v59
    v_mov_b32 v212, v59
    v_mov_b32 v244, v59
    v_mov_b32 v213, v59
    v_mov_b32 v245, v59
    v_mov_b32 v214, v59
    v_mov_b32 v246, v59
    v_mov_b32 v215, v59
    v_mov_b32 v247, v59
    v_mov_b32 v216, v59
    v_mov_b32 v248, v59
    v_mov_b32 v217, v59
    v_mov_b32 v249, v59
    v_mov_b32 v218, v59
    v_mov_b32 v250, v59
    v_mov_b32 v219, v59
    v_mov_b32 v251, v59
    v_mov_b32 v220, v59
    v_mov_b32 v252, v59
    v_mov_b32 v221, v59
    v_mov_b32 v253, v59
    v_mov_b32 v222, v59
    v_mov_b32 v254, v59
    v_mov_b32 v223, v59
    v_mov_b32 v255, v59
    s_nop 1
L_hook_61:
    v_mfma_f32_32x32x16_bf16 v[64:79], v[24:27], v[16:19], v[240:255]
    v_exp_f32 v84, v84
    v_exp_f32 v85, v85
    v_cvt_pk_bf16_f32 v104, v80, v81
    v_cvt_pk_bf16_f32 v105, v82, v83
    v_exp_f32 v86, v86
    v_exp_f32 v87, v87
    v_mfma_f32_32x32x16_bf16 v[64:79], v[32:35], v[20:23], v[64:79]
    v_exp_f32 v88, v88
    v_exp_f32 v89, v89
    v_cvt_pk_bf16_f32 v106, v84, v85
    v_cvt_pk_bf16_f32 v107, v86, v87
    v_exp_f32 v90, v90
    v_exp_f32 v91, v91
    v_mfma_f32_32x32x16_bf16 v[112:127], v[44:47], v[100:103], v[112:127]
    v_exp_f32 v92, v92
    v_exp_f32 v93, v93
    v_cvt_pk_bf16_f32 v108, v88, v89
    v_cvt_pk_bf16_f32 v109, v90, v91
    v_exp_f32 v94, v94
    v_exp_f32 v95, v95
    s_waitcnt lgkmcnt(0)
    v_mfma_f32_32x32x16_bf16 v[112:127], v[48:51], v[104:107], v[112:127]
    ds_read_b64_tr_b16 v[40:41], v194 offset:512
    ds_read_b64_tr_b16 v[42:43], v194 offset:640
    ds_read_b64_tr_b16 v[44:45], v194 offset:768
    ds_read_b64_tr_b16 v[46:47], v194 offset:896
    v_exp_f32 v64, v64
    v_exp_f32 v65, v65
    v_cvt_pk_bf16_f32 v110, v92, v93
    v_cvt_pk_bf16_f32 v111, v94, v95
    v_exp_f32 v66, v66
    v_exp_f32 v67, v67
    v_mfma_f32_32x32x16_bf16 v[112:127], v[52:55], v[108:111], v[112:127]
    v_exp_f32 v68, v68
    v_exp_f32 v69, v69
    v_cvt_pk_bf16_f32 v96, v64, v65
    v_cvt_pk_bf16_f32 v97, v66, v67
    v_exp_f32 v70, v70
    v_exp_f32 v71, v71
    v_exp_f32 v72, v72
    v_exp_f32 v73, v73
    v_cvt_pk_bf16_f32 v98, v68, v69
    v_cvt_pk_bf16_f32 v99, v70, v71
    v_exp_f32 v74, v74
    v_exp_f32 v75, v75
    s_waitcnt lgkmcnt(0)
    v_mfma_f32_32x32x16_bf16 v[112:127], v[40:43], v[96:99], v[112:127]
    v_exp_f32 v76, v76
    v_exp_f32 v77, v77
    v_cvt_pk_bf16_f32 v100, v72, v73
    v_cvt_pk_bf16_f32 v101, v74, v75
    v_exp_f32 v78, v78
    v_exp_f32 v79, v79
    v_cvt_pk_bf16_f32 v102, v76, v77
    v_cvt_pk_bf16_f32 v103, v78, v79
    s_nop 1
    v_mfma_f32_32x32x16_bf16 v[112:127], v[44:47], v[100:103], v[112:127]
    s_nop 10
    s_branch L_a2_done
.section .rodata,"a"
.p2align 6
.amdhsa_kernel concat_heads__sliding_block__ssm_conv_h3__prompt_kernel
  .amdhsa_next_free_vgpr 256
  .amdhsa_next_free_sgpr 102
  .amdhsa_accum_offset 256
  .amdhsa_group_segment_fixed_size 0
  .amdhsa_kernarg_size 96
  .amdhsa_user_sgpr_count 2
  .amdhsa_user_sgpr_kernarg_segment_ptr 1
  .amdhsa_system_sgpr_workgroup_id_x 1
.end_amdhsa_kernel
```
